```python
import torch

def _softmax(x, axis=-1):
    return torch.softmax(x, dim=axis)
def _gelu(x):
    return torch.nn.functional.gelu(x, approximate="tanh")
def _silu(x):
    return torch.nn.functional.silu(x)
def _sigmoid(x):
    return torch.sigmoid(x)
def _layernorm(x, axis=-1, eps=1e-5):
    m = x.mean(dim=axis, keepdim=True)
    v = x.var(dim=axis, keepdim=True, unbiased=False)
    return (x - m) / torch.sqrt(v + eps)
def _scatter_add(tgt, idx, src, axis=0):
    return tgt.clone().index_add_(axis, idx, src)
def _segment_sum(src, seg, n):
    out = torch.zeros((n,) + src.shape[1:], dtype=src.dtype)
    return out.index_add_(0, seg, src)
def _pad(x, pw):
    flat = tuple(v for pair in reversed(pw) for v in pair)
    return torch.nn.functional.pad(x, flat)

kernel_name = 'sequential_preLN__softmax_full_mha__glu_gated_reglu__prompt'

def setup_inputs():

    _w = (lambda a: (lambda t: t.to(torch.bfloat16) if t.is_floating_point() else t)(torch.as_tensor(a)))
    def _A_setup():
        B, S, D = 1, 2048, 512
        return {
            "x": _w((lambda *s: torch.randn(*s, dtype=torch.bfloat16) * 0.05)(B, S, D)),
            "wqkv": _w((lambda *s: torch.randn(*s, dtype=torch.bfloat16) * 0.05)(D, 3 * D)),
            "wo": _w((lambda *s: torch.randn(*s, dtype=torch.bfloat16) * 0.05)(D, D)),
        }
    _A_in = _A_setup()

    def _B_setup():
        B, S, D, F = 1, 2048, 512, 1376
        return {
            "x": _w((lambda *s: torch.randn(*s, dtype=torch.bfloat16) * 0.05)(B, S, D)),
            "W_gate": _w((lambda *s: torch.randn(*s, dtype=torch.bfloat16) * 0.4)(D, F) * (2.0 / D) ** 0.5),
            "W_up": _w((lambda *s: torch.randn(*s, dtype=torch.bfloat16) * 0.4)(D, F) * (2.0 / D) ** 0.5),
            "W_down": _w((lambda *s: torch.randn(*s, dtype=torch.bfloat16) * 0.4)(F, D) * (1.0 / F) ** 0.5),
        }
    _B_in = _B_setup()

    return {
        "A_x": _A_in["x"],
        "A_wqkv": _A_in["wqkv"],
        "A_wo": _A_in["wo"],
        "B_x": _B_in["x"],
        "B_W_gate": _B_in["W_gate"],
        "B_W_up": _B_in["W_up"],
        "B_W_down": _B_in["W_down"],
    }

def reference(A_x, A_wqkv, A_wo, B_x, B_W_gate, B_W_up, B_W_down):
    def _A_ref(x, wqkv, wo):
        B, S, D = x.shape
        H = 32; Dh = D // H
        qkv = (lambda x, *d: x.permute(*d))((x @ wqkv).reshape(B, S, 3, H, Dh), 2, 0, 3, 1, 4)
        q, k, v = qkv[0], qkv[1], qkv[2]
        scale = Dh ** -0.5
        scores = torch.einsum("bhqd,bhkd->bhqk", q, k) * scale
        p = _softmax(scores, axis=-1)
        o = torch.einsum("bhqk,bhkd->bhqd", p, v)
        return (lambda x, *d: x.permute(*d))(o, 0, 2, 1, 3).reshape(B, S, D) @ wo

    def _B_ref(x, W_gate, W_up, W_down):
        gate = torch.einsum("bsd,df->bsf", x, W_gate)
        up = torch.einsum("bsd,df->bsf", x, W_up)
        gate = gate * (lambda x, dt: x.to(dt))(gate > 0, gate.dtype)
        h = gate * up
        return torch.einsum("bsf,fd->bsd", h, W_down)

    x = A_x
    h = x + _A_ref(_layernorm(x, axis=-1), A_wqkv, A_wo)
    h2 = h + _B_ref(_layernorm(h, axis=-1), B_W_gate, B_W_up, B_W_down)
    return h2
```

```asm
; @launch grid=(256,1,1) block=(768,1,1) lds=163840
.amdgcn_target "amdgcn-amd-amdhsa--gfx950"
.text
.globl sequential_preLN__softmax_full_mha__glu_gated_reglu__prompt_kernel
.p2align 8
.type sequential_preLN__softmax_full_mha__glu_gated_reglu__prompt_kernel,@function
sequential_preLN__softmax_full_mha__glu_gated_reglu__prompt_kernel:
  s_load_dwordx4 s[4:7], s[0:1], 0
  s_load_dwordx4 s[60:63], s[0:1], 64
  s_load_dwordx8 s[8:15], s[0:1], 16
  s_load_dwordx4 s[16:19], s[0:1], 48
  s_cmp_ge_u32 s2, 256
  s_cbranch_scc1 sequential_preLN__softmax_full_mha__glu_gated_reglu__prompt_kernel_done1
  v_lshrrev_b32 v1, 6, v0
  v_and_b32 v2, 63, v0
  s_getreg_b32 s24, hwreg(HW_REG_XCC_ID, 0, 3)
  s_getreg_b32 s25, hwreg(HW_REG_HW_ID, 13, 2)
  v_readfirstlane_b32 s26, v1
  s_getreg_b32 s29, hwreg(HW_REG_HW_ID, 8, 4)
  v_lshlrev_b32 v3, 4, v2
  s_lshl_b32 s25, s25, 3
  s_cmp_ge_u32 s29, 8
  s_cselect_b32 s49, 1, 0
  s_mov_b32 s1, s29
  s_and_b32 s29, s29, 7
  s_or_b32 s25, s25, s29
  s_mov_b32 s3, 0
  s_mov_b32 s50, 20480
  s_mov_b32 s51, -143360
  s_lshr_b32 s29, s26, 1
  s_andn2_b32 s29, 4, s29
  s_xor_b32 s26, s26, s29
sequential_preLN__softmax_full_mha__glu_gated_reglu__prompt_kernel_restart:
  s_mov_b32 s27, s25
  s_mov_b32 s28, s24
  s_cmp_ge_u32 s26, 8
  s_cbranch_scc1 sequential_preLN__softmax_full_mha__glu_gated_reglu__prompt_kernel_H3
  s_cmp_lt_u32 s26, 4
  s_cbranch_scc1 sequential_preLN__softmax_full_mha__glu_gated_reglu__prompt_kernel_C5
  s_sub_u32 s29, s26, 4
  v_lshrrev_b32 v11, 3, v2
  v_and_b32 v4, 7, v2
  v_lshrrev_b32 v5, 4, v2
  v_xor_b32 v6, v4, v5
  v_lshlrev_b32 v6, 4, v6
  s_lshl_b32 s35, s29, 4
  v_add_u32 v7, s35, v11
  v_lshlrev_b32 v12, 10, v7
  v_add_u32 v8, v12, v6
  v_xor_b32 v6, 64, v6
  v_add_u32 v9, v12, v6
  v_add_u32 v9, 8192, v9
  s_lshl_b32 s35, s29, 3
  v_add_u32 v7, s35, v11
  v_and_b32 v5, 3, v11
  v_lshlrev_b32 v5, 1, v5
  v_xor_b32 v5, v4, v5
  v_lshlrev_b32 v5, 4, v5
  v_mul_u32_u24 v7, 3072, v7
  v_add_u32 v10, v7, v5
  s_lshl_b32 s31, s29, 10
  s_lshl_b32 s36, s29, 11
  s_lshl_b32 s30, s27, 16
  s_lshl_b32 s32, s28, 7
  s_mov_b32 s54, 0x200000
  s_mov_b32 s55, 0x20000
  s_mov_b32 s58, 1572864
  s_mov_b32 s59, 0x20000
  s_waitcnt lgkmcnt(0)
  s_mov_b32 s52, s4
  s_and_b32 s53, s5, 0xffff
  s_mov_b32 s56, s6
  s_and_b32 s57, s7, 0xffff
  s_add_u32 s37, s27, 0
  s_and_b32 s37, s37, 7
  s_lshl_b32 s33, s37, 7
  s_add_u32 s33, s33, s30
  s_add_u32 m0, s36, 0
  s_nop 0
  buffer_load_dwordx4 v8, s[52:55], s33 offen  lds
  s_add_u32 m0, s36, 1024
  s_nop 0
  buffer_load_dwordx4 v9, s[52:55], s33 offen  lds
  s_add_u32 s37, s27, 0
  s_and_b32 s37, s37, 7
  s_mul_i32 s37, s37, 196608
  s_add_u32 s37, s37, s32
  s_add_u32 s33, s37, 0
  s_add_u32 m0, s31, 65536
  s_nop 0
  buffer_load_dwordx4 v10, s[56:59], s33 offen  lds
  s_add_u32 s33, s37, 1024
  s_add_u32 m0, s31, 69632
  s_nop 0
  buffer_load_dwordx4 v10, s[56:59], s33 offen  lds
  s_add_u32 s33, s37, 2048
  s_add_u32 m0, s31, 73728
  s_nop 0
  buffer_load_dwordx4 v10, s[56:59], s33 offen  lds
  s_add_u32 s37, s27, 0
  s_and_b32 s37, s37, 7
  s_mul_i32 s37, s37, 196608
  s_add_u32 s37, s37, s32
  s_add_u32 s33, s37, 98304
  s_add_u32 m0, s31, 77824
  s_nop 0
  buffer_load_dwordx4 v10, s[56:59], s33 offen  lds
  s_add_u32 s33, s37, 99328
  s_add_u32 m0, s31, 81920
  s_nop 0
  buffer_load_dwordx4 v10, s[56:59], s33 offen  lds
  s_add_u32 s33, s37, 100352
  s_add_u32 m0, s31, 86016
  s_nop 0
  buffer_load_dwordx4 v10, s[56:59], s33 offen  lds
  s_add_u32 s37, s27, 1
  s_and_b32 s37, s37, 7
  s_lshl_b32 s33, s37, 7
  s_add_u32 s33, s33, s30
  s_add_u32 m0, s36, 8192
  s_nop 0
  buffer_load_dwordx4 v8, s[52:55], s33 offen  lds
  s_add_u32 m0, s36, 9216
  s_nop 0
  buffer_load_dwordx4 v9, s[52:55], s33 offen  lds
  s_add_u32 s37, s27, 1
  s_and_b32 s37, s37, 7
  s_mul_i32 s37, s37, 196608
  s_add_u32 s37, s37, s32
  s_add_u32 s33, s37, 0
  s_add_u32 m0, s31, 90112
  s_nop 0
  buffer_load_dwordx4 v10, s[56:59], s33 offen  lds
  s_add_u32 s33, s37, 1024
  s_add_u32 m0, s31, 94208
  s_nop 0
  buffer_load_dwordx4 v10, s[56:59], s33 offen  lds
  s_add_u32 s33, s37, 2048
  s_add_u32 m0, s31, 98304
  s_nop 0
  buffer_load_dwordx4 v10, s[56:59], s33 offen  lds
  s_add_u32 s37, s27, 1
  s_and_b32 s37, s37, 7
  s_mul_i32 s37, s37, 196608
  s_add_u32 s37, s37, s32
  s_add_u32 s33, s37, 98304
  s_add_u32 m0, s31, 102400
  s_nop 0
  buffer_load_dwordx4 v10, s[56:59], s33 offen  lds
  s_add_u32 s33, s37, 99328
  s_add_u32 m0, s31, 106496
  s_nop 0
  buffer_load_dwordx4 v10, s[56:59], s33 offen  lds
  s_add_u32 s33, s37, 100352
  s_add_u32 m0, s31, 110592
  s_nop 0
  buffer_load_dwordx4 v10, s[56:59], s33 offen  lds
  s_mov_b32 s20, s62
  s_and_b32 s21, s63, 0xffff
  s_mov_b32 s22, 33554432
  s_mov_b32 s23, 0x20000
  s_waitcnt vmcnt(8)
  s_barrier
  s_cmp_eq_u32 s49, 1
  s_cbranch_scc1 sequential_preLN__softmax_full_mha__glu_gated_reglu__prompt_kernel_ec6
sequential_preLN__softmax_full_mha__glu_gated_reglu__prompt_kernel_ecb7:
  s_add_u32 s37, s27, 2
  s_and_b32 s37, s37, 7
  s_lshl_b32 s33, s37, 7
  s_add_u32 s33, s33, s30
  s_add_u32 m0, s36, 16384
  s_nop 0
  buffer_load_dwordx4 v8, s[52:55], s33 offen  lds
  s_add_u32 m0, s36, 17408
  s_nop 0
  buffer_load_dwordx4 v9, s[52:55], s33 offen  lds
  s_add_u32 s37, s27, 2
  s_and_b32 s37, s37, 7
  s_mul_i32 s37, s37, 196608
  s_add_u32 s37, s37, s32
  s_add_u32 s33, s37, 0
  s_add_u32 m0, s31, 114688
  s_nop 0
  buffer_load_dwordx4 v10, s[56:59], s33 offen  lds
  s_add_u32 s33, s37, 1024
  s_add_u32 m0, s31, 118784
  s_nop 0
  buffer_load_dwordx4 v10, s[56:59], s33 offen  lds
  s_add_u32 s33, s37, 2048
  s_add_u32 m0, s31, 122880
  s_nop 0
  buffer_load_dwordx4 v10, s[56:59], s33 offen  lds
  s_add_u32 s37, s27, 2
  s_and_b32 s37, s37, 7
  s_mul_i32 s37, s37, 196608
  s_add_u32 s37, s37, s32
  s_add_u32 s33, s37, 98304
  s_add_u32 m0, s31, 126976
  s_nop 0
  buffer_load_dwordx4 v10, s[56:59], s33 offen  lds
  s_add_u32 s33, s37, 99328
  s_add_u32 m0, s31, 131072
  s_nop 0
  buffer_load_dwordx4 v10, s[56:59], s33 offen  lds
  s_add_u32 s33, s37, 100352
  s_add_u32 m0, s31, 135168
  s_nop 0
  buffer_load_dwordx4 v10, s[56:59], s33 offen  lds
  s_waitcnt vmcnt(8)
  s_barrier
  s_cmp_eq_u32 s49, 1
  s_cbranch_scc1 sequential_preLN__softmax_full_mha__glu_gated_reglu__prompt_kernel_ec8
sequential_preLN__softmax_full_mha__glu_gated_reglu__prompt_kernel_ecb9:
  s_add_u32 s37, s27, 3
  s_and_b32 s37, s37, 7
  s_lshl_b32 s33, s37, 7
  s_add_u32 s33, s33, s30
  s_add_u32 m0, s36, 24576
  s_nop 0
  buffer_load_dwordx4 v8, s[52:55], s33 offen  lds
  s_add_u32 m0, s36, 25600
  s_nop 0
  buffer_load_dwordx4 v9, s[52:55], s33 offen  lds
  s_add_u32 s37, s27, 3
  s_and_b32 s37, s37, 7
  s_mul_i32 s37, s37, 196608
  s_add_u32 s37, s37, s32
  s_add_u32 s33, s37, 0
  s_add_u32 m0, s31, 139264
  s_nop 0
  buffer_load_dwordx4 v10, s[56:59], s33 offen  lds
  s_add_u32 s33, s37, 1024
  s_add_u32 m0, s31, 143360
  s_nop 0
  buffer_load_dwordx4 v10, s[56:59], s33 offen  lds
  s_add_u32 s33, s37, 2048
  s_add_u32 m0, s31, 147456
  s_nop 0
  buffer_load_dwordx4 v10, s[56:59], s33 offen  lds
  s_add_u32 s37, s27, 3
  s_and_b32 s37, s37, 7
  s_mul_i32 s37, s37, 196608
  s_add_u32 s37, s37, s32
  s_add_u32 s33, s37, 98304
  s_add_u32 m0, s31, 151552
  s_nop 0
  buffer_load_dwordx4 v10, s[56:59], s33 offen  lds
  s_add_u32 s33, s37, 99328
  s_add_u32 m0, s31, 155648
  s_nop 0
  buffer_load_dwordx4 v10, s[56:59], s33 offen  lds
  s_add_u32 s33, s37, 100352
  s_add_u32 m0, s31, 159744
  s_nop 0
  buffer_load_dwordx4 v10, s[56:59], s33 offen  lds
  s_waitcnt vmcnt(8)
  s_barrier
  s_cmp_eq_u32 s49, 1
  s_cbranch_scc1 sequential_preLN__softmax_full_mha__glu_gated_reglu__prompt_kernel_ec10
sequential_preLN__softmax_full_mha__glu_gated_reglu__prompt_kernel_ecb11:
  s_add_u32 s37, s27, 4
  s_and_b32 s37, s37, 7
  s_lshl_b32 s33, s37, 7
  s_add_u32 s33, s33, s30
  s_add_u32 m0, s36, 32768
  s_nop 0
  buffer_load_dwordx4 v8, s[52:55], s33 offen  lds
  s_add_u32 m0, s36, 33792
  s_nop 0
  buffer_load_dwordx4 v9, s[52:55], s33 offen  lds
  s_add_u32 s37, s27, 4
  s_and_b32 s37, s37, 7
  s_mul_i32 s37, s37, 196608
  s_add_u32 s37, s37, s32
  s_add_u32 s33, s37, 0
  s_add_u32 m0, s31, 65536
  s_nop 0
  buffer_load_dwordx4 v10, s[56:59], s33 offen  lds
  s_add_u32 s33, s37, 1024
  s_add_u32 m0, s31, 69632
  s_nop 0
  buffer_load_dwordx4 v10, s[56:59], s33 offen  lds
  s_add_u32 s33, s37, 2048
  s_add_u32 m0, s31, 73728
  s_nop 0
  buffer_load_dwordx4 v10, s[56:59], s33 offen  lds
  s_add_u32 s37, s27, 4
  s_and_b32 s37, s37, 7
  s_mul_i32 s37, s37, 196608
  s_add_u32 s37, s37, s32
  s_add_u32 s33, s37, 98304
  s_add_u32 m0, s31, 77824
  s_nop 0
  buffer_load_dwordx4 v10, s[56:59], s33 offen  lds
  s_add_u32 s33, s37, 99328
  s_add_u32 m0, s31, 81920
  s_nop 0
  buffer_load_dwordx4 v10, s[56:59], s33 offen  lds
  s_add_u32 s33, s37, 100352
  s_add_u32 m0, s31, 86016
  s_nop 0
  buffer_load_dwordx4 v10, s[56:59], s33 offen  lds
  s_waitcnt vmcnt(8)
  s_barrier
  s_cmp_eq_u32 s49, 1
  s_cbranch_scc1 sequential_preLN__softmax_full_mha__glu_gated_reglu__prompt_kernel_ec12
sequential_preLN__softmax_full_mha__glu_gated_reglu__prompt_kernel_ecb13:
  s_add_u32 s37, s27, 5
  s_and_b32 s37, s37, 7
  s_lshl_b32 s33, s37, 7
  s_add_u32 s33, s33, s30
  s_add_u32 m0, s36, 40960
  s_nop 0
  buffer_load_dwordx4 v8, s[52:55], s33 offen  lds
  s_add_u32 m0, s36, 41984
  s_nop 0
  buffer_load_dwordx4 v9, s[52:55], s33 offen  lds
  s_add_u32 s37, s27, 5
  s_and_b32 s37, s37, 7
  s_mul_i32 s37, s37, 196608
  s_add_u32 s37, s37, s32
  s_add_u32 s33, s37, 0
  s_add_u32 m0, s31, 90112
  s_nop 0
  buffer_load_dwordx4 v10, s[56:59], s33 offen  lds
  s_add_u32 s33, s37, 1024
  s_add_u32 m0, s31, 94208
  s_nop 0
  buffer_load_dwordx4 v10, s[56:59], s33 offen  lds
  s_add_u32 s33, s37, 2048
  s_add_u32 m0, s31, 98304
  s_nop 0
  buffer_load_dwordx4 v10, s[56:59], s33 offen  lds
  s_add_u32 s37, s27, 5
  s_and_b32 s37, s37, 7
  s_mul_i32 s37, s37, 196608
  s_add_u32 s37, s37, s32
  s_add_u32 s33, s37, 98304
  s_add_u32 m0, s31, 102400
  s_nop 0
  buffer_load_dwordx4 v10, s[56:59], s33 offen  lds
  s_add_u32 s33, s37, 99328
  s_add_u32 m0, s31, 106496
  s_nop 0
  buffer_load_dwordx4 v10, s[56:59], s33 offen  lds
  s_add_u32 s33, s37, 100352
  s_add_u32 m0, s31, 110592
  s_nop 0
  buffer_load_dwordx4 v10, s[56:59], s33 offen  lds
  s_waitcnt vmcnt(8)
  s_barrier
  s_cmp_eq_u32 s49, 1
  s_cbranch_scc1 sequential_preLN__softmax_full_mha__glu_gated_reglu__prompt_kernel_ec14
sequential_preLN__softmax_full_mha__glu_gated_reglu__prompt_kernel_ecb15:
  s_add_u32 s37, s27, 6
  s_and_b32 s37, s37, 7
  s_lshl_b32 s33, s37, 7
  s_add_u32 s33, s33, s30
  s_add_u32 m0, s36, 49152
  s_nop 0
  buffer_load_dwordx4 v8, s[52:55], s33 offen  lds
  s_add_u32 m0, s36, 50176
  s_nop 0
  buffer_load_dwordx4 v9, s[52:55], s33 offen  lds
  s_add_u32 s37, s27, 6
  s_and_b32 s37, s37, 7
  s_mul_i32 s37, s37, 196608
  s_add_u32 s37, s37, s32
  s_add_u32 s33, s37, 0
  s_add_u32 m0, s31, 114688
  s_nop 0
  buffer_load_dwordx4 v10, s[56:59], s33 offen  lds
  s_add_u32 s33, s37, 1024
  s_add_u32 m0, s31, 118784
  s_nop 0
  buffer_load_dwordx4 v10, s[56:59], s33 offen  lds
  s_add_u32 s33, s37, 2048
  s_add_u32 m0, s31, 122880
  s_nop 0
  buffer_load_dwordx4 v10, s[56:59], s33 offen  lds
  s_add_u32 s37, s27, 6
  s_and_b32 s37, s37, 7
  s_mul_i32 s37, s37, 196608
  s_add_u32 s37, s37, s32
  s_add_u32 s33, s37, 98304
  s_add_u32 m0, s31, 126976
  s_nop 0
  buffer_load_dwordx4 v10, s[56:59], s33 offen  lds
  s_add_u32 s33, s37, 99328
  s_add_u32 m0, s31, 131072
  s_nop 0
  buffer_load_dwordx4 v10, s[56:59], s33 offen  lds
  s_add_u32 s33, s37, 100352
  s_add_u32 m0, s31, 135168
  s_nop 0
  buffer_load_dwordx4 v10, s[56:59], s33 offen  lds
  s_waitcnt vmcnt(8)
  s_barrier
  s_add_u32 s37, s27, 7
  s_and_b32 s37, s37, 7
  s_lshl_b32 s33, s37, 7
  s_add_u32 s33, s33, s30
  s_add_u32 m0, s36, 57344
  s_nop 0
  buffer_load_dwordx4 v8, s[52:55], s33 offen  lds
  s_add_u32 m0, s36, 58368
  s_nop 0
  buffer_load_dwordx4 v9, s[52:55], s33 offen  lds
  s_add_u32 s37, s27, 7
  s_and_b32 s37, s37, 7
  s_mul_i32 s37, s37, 196608
  s_add_u32 s37, s37, s32
  s_add_u32 s33, s37, 0
  s_add_u32 m0, s31, 139264
  s_nop 0
  buffer_load_dwordx4 v10, s[56:59], s33 offen  lds
  s_add_u32 s33, s37, 1024
  s_add_u32 m0, s31, 143360
  s_nop 0
  buffer_load_dwordx4 v10, s[56:59], s33 offen  lds
  s_add_u32 s33, s37, 2048
  s_add_u32 m0, s31, 147456
  s_nop 0
  buffer_load_dwordx4 v10, s[56:59], s33 offen  lds
  s_add_u32 s37, s27, 7
  s_and_b32 s37, s37, 7
  s_mul_i32 s37, s37, 196608
  s_add_u32 s37, s37, s32
  s_add_u32 s33, s37, 98304
  s_add_u32 m0, s31, 151552
  s_nop 0
  buffer_load_dwordx4 v10, s[56:59], s33 offen  lds
  s_add_u32 s33, s37, 99328
  s_add_u32 m0, s31, 155648
  s_nop 0
  buffer_load_dwordx4 v10, s[56:59], s33 offen  lds
  s_add_u32 s33, s37, 100352
  s_add_u32 m0, s31, 159744
  s_nop 0
  buffer_load_dwordx4 v10, s[56:59], s33 offen  lds
  s_waitcnt vmcnt(8)
  s_barrier
  s_waitcnt vmcnt(0)
  s_barrier
  s_barrier
  s_barrier
  v_mov_b32 v1, 163832
  ds_read_b32 v1, v1
  s_waitcnt lgkmcnt(0)
  v_readfirstlane_b32 s0, v1
  s_nop 0
  s_cmp_eq_u32 s0, 0
  s_cbranch_scc1 sequential_preLN__softmax_full_mha__glu_gated_reglu__prompt_kernel_rok16
  s_branch sequential_preLN__softmax_full_mha__glu_gated_reglu__prompt_kernel_redo
sequential_preLN__softmax_full_mha__glu_gated_reglu__prompt_kernel_rok16:
  s_lshl_b32 s62, s24, 2
  s_and_b32 s63, s25, 3
  s_add_u32 s62, s62, s63
  s_lshr_b32 s63, s25, 2
  s_barrier
  s_branch sequential_preLN__softmax_full_mha__glu_gated_reglu__prompt_kernel_p24
sequential_preLN__softmax_full_mha__glu_gated_reglu__prompt_kernel_H3:
  s_setprio 3
  s_waitcnt lgkmcnt(0)
  s_mov_b32 s20, s62
  s_and_b32 s21, s63, 0xffff
  s_mov_b32 s22, 33554432
  s_mov_b32 s23, 0x20000
  s_lshl_b32 s57, s3, 8
  s_or_b32 s57, s57, s26
  s_cmp_lg_u32 s57, 8
  s_cbranch_scc1 sequential_preLN__softmax_full_mha__glu_gated_reglu__prompt_kernel_initd18
  s_lshl_b32 s30, s2, 7
  s_add_u32 s30, s30, 26279936
  v_lshl_add_u32 v4, v2, 15, s30
  s_and_b32 s30, s2, 7
  s_lshl_b32 s30, s30, 8
  s_add_u32 s30, s30, 26226688
  v_mov_b32 v5, 0
  v_writelane_b32 v4, s30, 4
  s_mov_b64 exec, 31
  buffer_store_dword v5, v4, s[20:23], 0 offen sc1
  s_mov_b64 exec, -1
sequential_preLN__softmax_full_mha__glu_gated_reglu__prompt_kernel_initd18:
  s_sub_u32 s29, s26, 8
  s_lshl_b32 s30, s29, 10
  v_add_u32 v4, s30, v3
  s_mov_b32 s39, 0x3f803f80
  s_cmp_lg_u32 s57, 9
  s_cbranch_scc1 sequential_preLN__softmax_full_mha__glu_gated_reglu__prompt_kernel_h919
  s_lshl_b32 s30, s24, 2
  s_lshr_b32 s31, s25, 3
  s_add_u32 s30, s30, s31
  s_lshl_b32 s30, s30, 7
  s_add_u32 s30, s30, 26247168
  s_lshl_b32 s31, s1, 3
  s_mov_b64 exec, 1
  v_mov_b32 v50, s31
  v_mov_b32 v52, 0x5ca1ab1e
  v_mov_b32 v53, 0xb5e55ed
  buffer_store_dwordx2 v[52:53], v50, s[20:23], s30 offen
  s_mov_b64 exec, -1
sequential_preLN__softmax_full_mha__glu_gated_reglu__prompt_kernel_h919:
  s_cmp_lg_u32 s57, 10
  s_cbranch_scc1 sequential_preLN__softmax_full_mha__glu_gated_reglu__prompt_kernel_hi20
  s_cmp_lg_u32 s49, 1
  s_cbranch_scc1 sequential_preLN__softmax_full_mha__glu_gated_reglu__prompt_kernel_hi20
  s_lshl_b32 s30, s24, 2
  s_lshr_b32 s31, s25, 3
  s_add_u32 s30, s30, s31
  s_lshl_b32 s30, s30, 7
  s_add_u32 s30, s30, 26247168
  v_lshlrev_b32 v50, 3, v2
  s_mov_b32 s41, 0
  s_mov_b32 s32, 0xb5e55ed
  s_mov_b64 exec, 0xff
sequential_preLN__softmax_full_mha__glu_gated_reglu__prompt_kernel_hil21:
  s_sleep 4
  buffer_load_dwordx2 v[52:53], v50, s[20:23], s30 offen sc1
  s_mov_b32 s56, 0
  s_add_u32 s41, s41, 1
  s_cmp_gt_u32 s41, 3
  s_cbranch_scc1 sequential_preLN__softmax_full_mha__glu_gated_reglu__prompt_kernel_hiw22
  s_waitcnt vmcnt(0)
  v_cmp_eq_u32 vcc, 0x5ca1ab1e, v52
  v_cmp_eq_u32 s[34:35], s32, v53
  s_nop 0
  s_and_b32 s31, vcc_lo, s34
  s_bcnt1_i32_b32 s33, s31
  s_cmp_lg_u32 s33, 7
  s_cbranch_scc1 sequential_preLN__softmax_full_mha__glu_gated_reglu__prompt_kernel_hil21
  s_ff0_i32_b32 s31, s31
  s_add_u32 s56, s31, s25
  s_or_b32 s56, s56, 0x100
  s_cmp_eq_u32 s31, 0
  s_cselect_b32 s56, 2, s56
sequential_preLN__softmax_full_mha__glu_gated_reglu__prompt_kernel_hiw22:
  s_mov_b64 exec, -1
  v_mov_b32 v50, 65528
  v_mov_b32 v49, s56
  ds_write_b32 v50, v49
  s_waitcnt vmcnt(0) lgkmcnt(0)
sequential_preLN__softmax_full_mha__glu_gated_reglu__prompt_kernel_hi20:
  s_cmp_lg_u32 s57, 8
  s_cbranch_scc1 sequential_preLN__softmax_full_mha__glu_gated_reglu__prompt_kernel_mk23
  s_lshl_b32 s30, s24, 5
  s_lshr_b32 s31, s25, 3
  s_cmp_lg_u32 s49, 0
  s_cselect_b32 s31, s31, s25
  s_cselect_b32 s32, 4, 0
  s_add_u32 s30, s30, s32
  s_lshl_b32 s31, 1, s31
  s_mov_b64 exec, 1
  v_mov_b32 v45, s30
  v_mov_b32 v46, s31
  s_waitcnt vmcnt(0)
  global_atomic_or v45, v46, s[60:61] offset:16 sc1
  s_mov_b64 exec, -1
sequential_preLN__softmax_full_mha__glu_gated_reglu__prompt_kernel_mk23:
  s_barrier
  s_cmp_eq_u32 s49, 1
  s_cbranch_scc1 sequential_preLN__softmax_full_mha__glu_gated_reglu__prompt_kernel_ec24
sequential_preLN__softmax_full_mha__glu_gated_reglu__prompt_kernel_ecb25:
  s_cmp_lg_u32 s26, 10
  s_cbranch_scc1 sequential_preLN__softmax_full_mha__glu_gated_reglu__prompt_kernel_pk26
  s_cmp_lg_u32 s49, 1
  s_cbranch_scc1 sequential_preLN__softmax_full_mha__glu_gated_reglu__prompt_kernel_pk26
  s_lshl_b32 s30, s24, 5
  v_mov_b32 v47, s30
  v_mov_b32 v50, 65532
  s_mov_b32 s56, 0
sequential_preLN__softmax_full_mha__glu_gated_reglu__prompt_kernel_pkw27:
  v_mov_b32 v49, s56
  ds_write_b32 v50, v49
  global_load_dword v48, v47, s[60:61] offset:16 sc1
  s_waitcnt lgkmcnt(0)
sequential_preLN__softmax_full_mha__glu_gated_reglu__prompt_kernel_pk26:
  ds_read_b128 v[16:19], v4 offset:0
  ds_read_b128 v[20:23], v4 offset:4096
  s_waitcnt lgkmcnt(1)
  v_dot2_f32_bf16 v24, v16, v16, 0
  v_dot2_f32_bf16 v28, v16, s39, 0
  v_dot2_f32_bf16 v25, v17, v17, 0
  v_dot2_f32_bf16 v29, v17, s39, 0
  v_dot2_f32_bf16 v24, v18, v18, v24
  v_dot2_f32_bf16 v28, v18, s39, v28
  v_dot2_f32_bf16 v25, v19, v19, v25
  v_dot2_f32_bf16 v29, v19, s39, v29
  s_waitcnt lgkmcnt(0)
  v_dot2_f32_bf16 v26, v20, v20, 0
  v_dot2_f32_bf16 v30, v20, s39, 0
  v_dot2_f32_bf16 v27, v21, v21, 0
  v_dot2_f32_bf16 v31, v21, s39, 0
  v_dot2_f32_bf16 v26, v22, v22, v26
  v_dot2_f32_bf16 v30, v22, s39, v30
  v_dot2_f32_bf16 v27, v23, v23, v27
  v_dot2_f32_bf16 v31, v23, s39, v31
  s_barrier
  s_cmp_eq_u32 s49, 1
  s_cbranch_scc1 sequential_preLN__softmax_full_mha__glu_gated_reglu__prompt_kernel_ec28
sequential_preLN__softmax_full_mha__glu_gated_reglu__prompt_kernel_ecb29:
  s_cmp_lg_u32 s26, 10
  s_cbranch_scc1 sequential_preLN__softmax_full_mha__glu_gated_reglu__prompt_kernel_pk30
  s_cmp_lg_u32 s49, 1
  s_cbranch_scc1 sequential_preLN__softmax_full_mha__glu_gated_reglu__prompt_kernel_pk30
  s_lshl_b32 s30, s24, 5
  v_mov_b32 v47, s30
  v_mov_b32 v50, 65528
  s_mov_b32 s56, 0
  s_waitcnt vmcnt(0)
  v_readfirstlane_b32 s30, v48
  s_nop 0
  s_lshr_b32 s30, s30, s25
  s_and_b32 s30, s30, 0xff
  s_bcnt1_i32_b32 s31, s30
  s_cmp_lg_u32 s31, 7
  s_cbranch_scc1 sequential_preLN__softmax_full_mha__glu_gated_reglu__prompt_kernel_pkw31
  s_ff0_i32_b32 s30, s30
  s_add_u32 s56, s30, s25
  s_or_b32 s56, s56, 0x100
  s_cmp_eq_u32 s30, 0
  s_cselect_b32 s56, 2, s56
sequential_preLN__softmax_full_mha__glu_gated_reglu__prompt_kernel_pkw31:
  v_mov_b32 v49, s56
  ds_write_b32 v50, v49
  global_load_dword v48, v47, s[60:61] offset:16 sc1
  s_waitcnt lgkmcnt(0)
sequential_preLN__softmax_full_mha__glu_gated_reglu__prompt_kernel_pk30:
  ds_read_b128 v[16:19], v4 offset:8192
  ds_read_b128 v[20:23], v4 offset:12288
  s_waitcnt lgkmcnt(1)
  v_dot2_f32_bf16 v24, v16, v16, v24
  v_dot2_f32_bf16 v28, v16, s39, v28
  v_dot2_f32_bf16 v25, v17, v17, v25
  v_dot2_f32_bf16 v29, v17, s39, v29
  v_dot2_f32_bf16 v24, v18, v18, v24
  v_dot2_f32_bf16 v28, v18, s39, v28
  v_dot2_f32_bf16 v25, v19, v19, v25
  v_dot2_f32_bf16 v29, v19, s39, v29
  s_waitcnt lgkmcnt(0)
  v_dot2_f32_bf16 v26, v20, v20, v26
  v_dot2_f32_bf16 v30, v20, s39, v30
  v_dot2_f32_bf16 v27, v21, v21, v27
  v_dot2_f32_bf16 v31, v21, s39, v31
  v_dot2_f32_bf16 v26, v22, v22, v26
  v_dot2_f32_bf16 v30, v22, s39, v30
  v_dot2_f32_bf16 v27, v23, v23, v27
  v_dot2_f32_bf16 v31, v23, s39, v31
  s_barrier
  s_cmp_eq_u32 s49, 1
  s_cbranch_scc1 sequential_preLN__softmax_full_mha__glu_gated_reglu__prompt_kernel_ec32
sequential_preLN__softmax_full_mha__glu_gated_reglu__prompt_kernel_ecb33:
  s_cmp_lg_u32 s26, 10
  s_cbranch_scc1 sequential_preLN__softmax_full_mha__glu_gated_reglu__prompt_kernel_pk34
  s_cmp_lg_u32 s49, 1
  s_cbranch_scc1 sequential_preLN__softmax_full_mha__glu_gated_reglu__prompt_kernel_pk34
  s_lshl_b32 s30, s24, 5
  v_mov_b32 v47, s30
  v_mov_b32 v50, 65532
  s_mov_b32 s56, 0
  s_waitcnt vmcnt(0)
  v_readfirstlane_b32 s30, v48
  s_nop 0
  s_lshr_b32 s30, s30, s25
  s_and_b32 s30, s30, 0xff
  s_bcnt1_i32_b32 s31, s30
  s_cmp_lg_u32 s31, 7
  s_cbranch_scc1 sequential_preLN__softmax_full_mha__glu_gated_reglu__prompt_kernel_pkw35
  s_ff0_i32_b32 s30, s30
  s_add_u32 s56, s30, s25
  s_or_b32 s56, s56, 0x100
  s_cmp_eq_u32 s30, 0
  s_cselect_b32 s56, 2, s56
sequential_preLN__softmax_full_mha__glu_gated_reglu__prompt_kernel_pkw35:
  v_mov_b32 v49, s56
  ds_write_b32 v50, v49
  global_load_dword v48, v47, s[60:61] offset:16 sc1
  s_waitcnt lgkmcnt(0)
sequential_preLN__softmax_full_mha__glu_gated_reglu__prompt_kernel_pk34:
  ds_read_b128 v[16:19], v4 offset:16384
  ds_read_b128 v[20:23], v4 offset:20480
  s_waitcnt lgkmcnt(1)
  v_dot2_f32_bf16 v24, v16, v16, v24
  v_dot2_f32_bf16 v28, v16, s39, v28
  v_dot2_f32_bf16 v25, v17, v17, v25
  v_dot2_f32_bf16 v29, v17, s39, v29
  v_dot2_f32_bf16 v24, v18, v18, v24
  v_dot2_f32_bf16 v28, v18, s39, v28
  v_dot2_f32_bf16 v25, v19, v19, v25
  v_dot2_f32_bf16 v29, v19, s39, v29
  s_waitcnt lgkmcnt(0)
  v_dot2_f32_bf16 v26, v20, v20, v26
  v_dot2_f32_bf16 v30, v20, s39, v30
  v_dot2_f32_bf16 v27, v21, v21, v27
  v_dot2_f32_bf16 v31, v21, s39, v31
  v_dot2_f32_bf16 v26, v22, v22, v26
  v_dot2_f32_bf16 v30, v22, s39, v30
  v_dot2_f32_bf16 v27, v23, v23, v27
  v_dot2_f32_bf16 v31, v23, s39, v31
  s_barrier
  s_cmp_eq_u32 s49, 1
  s_cbranch_scc1 sequential_preLN__softmax_full_mha__glu_gated_reglu__prompt_kernel_ec36
sequential_preLN__softmax_full_mha__glu_gated_reglu__prompt_kernel_ecb37:
  s_cmp_lg_u32 s26, 10
  s_cbranch_scc1 sequential_preLN__softmax_full_mha__glu_gated_reglu__prompt_kernel_pk38
  s_cmp_lg_u32 s49, 1
  s_cbranch_scc1 sequential_preLN__softmax_full_mha__glu_gated_reglu__prompt_kernel_pk38
  s_lshl_b32 s30, s24, 5
  v_mov_b32 v47, s30
  v_mov_b32 v50, 65528
  s_mov_b32 s56, 0
  s_waitcnt vmcnt(0)
  v_readfirstlane_b32 s30, v48
  s_nop 0
  s_lshr_b32 s30, s30, s25
  s_and_b32 s30, s30, 0xff
  s_bcnt1_i32_b32 s31, s30
  s_cmp_lg_u32 s31, 7
  s_cbranch_scc1 sequential_preLN__softmax_full_mha__glu_gated_reglu__prompt_kernel_pkw39
  s_ff0_i32_b32 s30, s30
  s_add_u32 s56, s30, s25
  s_or_b32 s56, s56, 0x100
  s_cmp_eq_u32 s30, 0
  s_cselect_b32 s56, 2, s56
sequential_preLN__softmax_full_mha__glu_gated_reglu__prompt_kernel_pkw39:
  v_mov_b32 v49, s56
  ds_write_b32 v50, v49
  s_waitcnt lgkmcnt(0)
sequential_preLN__softmax_full_mha__glu_gated_reglu__prompt_kernel_pk38:
  ds_read_b128 v[16:19], v4 offset:24576
  ds_read_b128 v[20:23], v4 offset:28672
  s_waitcnt lgkmcnt(1)
  v_dot2_f32_bf16 v24, v16, v16, v24
  v_dot2_f32_bf16 v28, v16, s39, v28
  v_dot2_f32_bf16 v25, v17, v17, v25
  v_dot2_f32_bf16 v29, v17, s39, v29
  v_dot2_f32_bf16 v24, v18, v18, v24
  v_dot2_f32_bf16 v28, v18, s39, v28
  v_dot2_f32_bf16 v25, v19, v19, v25
  v_dot2_f32_bf16 v29, v19, s39, v29
  s_waitcnt lgkmcnt(0)
  v_dot2_f32_bf16 v26, v20, v20, v26
  v_dot2_f32_bf16 v30, v20, s39, v30
  v_dot2_f32_bf16 v27, v21, v21, v27
  v_dot2_f32_bf16 v31, v21, s39, v31
  v_dot2_f32_bf16 v26, v22, v22, v26
  v_dot2_f32_bf16 v30, v22, s39, v30
  v_dot2_f32_bf16 v27, v23, v23, v27
  v_dot2_f32_bf16 v31, v23, s39, v31
  s_barrier
  s_cmp_eq_u32 s49, 1
  s_cbranch_scc1 sequential_preLN__softmax_full_mha__glu_gated_reglu__prompt_kernel_ec40
sequential_preLN__softmax_full_mha__glu_gated_reglu__prompt_kernel_ecb41:
  ds_read_b128 v[16:19], v4 offset:32768
  ds_read_b128 v[20:23], v4 offset:36864
  s_waitcnt lgkmcnt(1)
  v_dot2_f32_bf16 v24, v16, v16, v24
  v_dot2_f32_bf16 v28, v16, s39, v28
  v_dot2_f32_bf16 v25, v17, v17, v25
  v_dot2_f32_bf16 v29, v17, s39, v29
  v_dot2_f32_bf16 v24, v18, v18, v24
  v_dot2_f32_bf16 v28, v18, s39, v28
  v_dot2_f32_bf16 v25, v19, v19, v25
  v_dot2_f32_bf16 v29, v19, s39, v29
  s_waitcnt lgkmcnt(0)
  v_dot2_f32_bf16 v26, v20, v20, v26
  v_dot2_f32_bf16 v30, v20, s39, v30
  v_dot2_f32_bf16 v27, v21, v21, v27
  v_dot2_f32_bf16 v31, v21, s39, v31
  v_dot2_f32_bf16 v26, v22, v22, v26
  v_dot2_f32_bf16 v30, v22, s39, v30
  v_dot2_f32_bf16 v27, v23, v23, v27
  v_dot2_f32_bf16 v31, v23, s39, v31
  s_barrier
  ds_read_b128 v[16:19], v4 offset:40960
  ds_read_b128 v[20:23], v4 offset:45056
  s_waitcnt lgkmcnt(1)
  v_dot2_f32_bf16 v24, v16, v16, v24
  v_dot2_f32_bf16 v28, v16, s39, v28
  v_dot2_f32_bf16 v25, v17, v17, v25
  v_dot2_f32_bf16 v29, v17, s39, v29
  v_dot2_f32_bf16 v24, v18, v18, v24
  v_dot2_f32_bf16 v28, v18, s39, v28
  v_dot2_f32_bf16 v25, v19, v19, v25
  v_dot2_f32_bf16 v29, v19, s39, v29
  s_waitcnt lgkmcnt(0)
  v_dot2_f32_bf16 v26, v20, v20, v26
  v_dot2_f32_bf16 v30, v20, s39, v30
  v_dot2_f32_bf16 v27, v21, v21, v27
  v_dot2_f32_bf16 v31, v21, s39, v31
  v_dot2_f32_bf16 v26, v22, v22, v26
  v_dot2_f32_bf16 v30, v22, s39, v30
  v_dot2_f32_bf16 v27, v23, v23, v27
  v_dot2_f32_bf16 v31, v23, s39, v31
  s_barrier
  ds_read_b128 v[16:19], v4 offset:49152
  ds_read_b128 v[20:23], v4 offset:53248
  s_waitcnt lgkmcnt(1)
  v_dot2_f32_bf16 v24, v16, v16, v24
  v_dot2_f32_bf16 v28, v16, s39, v28
  v_dot2_f32_bf16 v25, v17, v17, v25
  v_dot2_f32_bf16 v29, v17, s39, v29
  v_dot2_f32_bf16 v24, v18, v18, v24
  v_dot2_f32_bf16 v28, v18, s39, v28
  v_dot2_f32_bf16 v25, v19, v19, v25
  v_dot2_f32_bf16 v29, v19, s39, v29
  s_waitcnt lgkmcnt(0)
  v_dot2_f32_bf16 v26, v20, v20, v26
  v_dot2_f32_bf16 v30, v20, s39, v30
  v_dot2_f32_bf16 v27, v21, v21, v27
  v_dot2_f32_bf16 v31, v21, s39, v31
  v_dot2_f32_bf16 v26, v22, v22, v26
  v_dot2_f32_bf16 v30, v22, s39, v30
  v_dot2_f32_bf16 v27, v23, v23, v27
  v_dot2_f32_bf16 v31, v23, s39, v31
  s_barrier
  s_cmp_lg_u32 s26, 11
  s_cbranch_scc1 sequential_preLN__softmax_full_mha__glu_gated_reglu__prompt_kernel_t11b42
  s_getpc_b64 s[44:45]
sequential_preLN__softmax_full_mha__glu_gated_reglu__prompt_kernel_here43:
  s_sub_u32 s44, s44, sequential_preLN__softmax_full_mha__glu_gated_reglu__prompt_kernel_here43-sequential_preLN__softmax_full_mha__glu_gated_reglu__prompt_kernel
  s_subb_u32 s45, s45, 0
  v_lshlrev_b32 v12, 7, v2
  v_add_u32 v12, 8192, v12
  global_load_dword v40, v12, s[44:45]
  v_add_u32 v12, 8192, v12
  global_load_dword v41, v12, s[44:45]
  v_add_u32 v12, 8192, v12
  global_load_dword v42, v12, s[44:45]
  v_add_u32 v12, 8192, v12
  global_load_dword v43, v12, s[44:45]
sequential_preLN__softmax_full_mha__glu_gated_reglu__prompt_kernel_t11b42:
  ds_read_b128 v[16:19], v4 offset:57344
  ds_read_b128 v[20:23], v4 offset:61440
  s_waitcnt lgkmcnt(1)
  v_dot2_f32_bf16 v24, v16, v16, v24
  v_dot2_f32_bf16 v28, v16, s39, v28
  v_dot2_f32_bf16 v25, v17, v17, v25
  v_dot2_f32_bf16 v29, v17, s39, v29
  v_dot2_f32_bf16 v24, v18, v18, v24
  v_dot2_f32_bf16 v28, v18, s39, v28
  v_dot2_f32_bf16 v25, v19, v19, v25
  v_dot2_f32_bf16 v29, v19, s39, v29
  s_waitcnt lgkmcnt(0)
  v_dot2_f32_bf16 v26, v20, v20, v26
  v_dot2_f32_bf16 v30, v20, s39, v30
  v_dot2_f32_bf16 v27, v21, v21, v27
  v_dot2_f32_bf16 v31, v21, s39, v31
  v_dot2_f32_bf16 v26, v22, v22, v26
  v_dot2_f32_bf16 v30, v22, s39, v30
  v_dot2_f32_bf16 v27, v23, v23, v27
  v_dot2_f32_bf16 v31, v23, s39, v31
  s_nop 2
  v_add_f32 v24, v24, v25
  v_add_f32 v26, v26, v27
  v_add_f32 v28, v28, v29
  v_add_f32 v30, v30, v31
  s_nop 1
  v_add_f32_dpp v24, v24, v24 quad_perm:[1,0,3,2] row_mask:0xf bank_mask:0xf
  v_add_f32_dpp v26, v26, v26 quad_perm:[1,0,3,2] row_mask:0xf bank_mask:0xf
  v_add_f32_dpp v28, v28, v28 quad_perm:[1,0,3,2] row_mask:0xf bank_mask:0xf
  v_add_f32_dpp v30, v30, v30 quad_perm:[1,0,3,2] row_mask:0xf bank_mask:0xf
  s_nop 1
  v_add_f32_dpp v24, v24, v24 quad_perm:[2,3,0,1] row_mask:0xf bank_mask:0xf
  v_add_f32_dpp v26, v26, v26 quad_perm:[2,3,0,1] row_mask:0xf bank_mask:0xf
  v_add_f32_dpp v28, v28, v28 quad_perm:[2,3,0,1] row_mask:0xf bank_mask:0xf
  v_add_f32_dpp v30, v30, v30 quad_perm:[2,3,0,1] row_mask:0xf bank_mask:0xf
  s_nop 1
  v_add_f32_dpp v24, v24, v24 row_half_mirror row_mask:0xf bank_mask:0xf
  v_add_f32_dpp v26, v26, v26 row_half_mirror row_mask:0xf bank_mask:0xf
  v_add_f32_dpp v28, v28, v28 row_half_mirror row_mask:0xf bank_mask:0xf
  v_add_f32_dpp v30, v30, v30 row_half_mirror row_mask:0xf bank_mask:0xf
  v_mul_f32 v28, 0x3b000000, v28
  v_mul_f32 v32, v28, v28
  v_mov_b32 v33, 0x3b000000
  v_fma_f32 v32, v24, v33, -v32
  v_max_f32 v32, 0, v32
  v_add_f32 v32, 0x3727c5ac, v32
  v_rsq_f32 v36, v32
  s_nop 0
  v_mul_f32 v38, v28, v36
  v_sub_f32 v38, 0, v38
  v_mul_f32 v30, 0x3b000000, v30
  v_mul_f32 v32, v30, v30
  v_mov_b32 v33, 0x3b000000
  v_fma_f32 v32, v26, v33, -v32
  v_max_f32 v32, 0, v32
  v_add_f32 v32, 0x3727c5ac, v32
  v_rsq_f32 v37, v32
  s_nop 0
  v_mul_f32 v39, v30, v37
  v_sub_f32 v39, 0, v39
  v_lshrrev_b32 v5, 3, v2
  s_lshl_b32 s30, s29, 5
  s_add_u32 s30, s30, 90112
  v_lshl_add_u32 v5, v5, 2, s30
  ds_write2_b32 v5, v36, v37 offset0:0 offset1:32
  ds_write2_b32 v5, v38, v39 offset0:64 offset1:96
  s_waitcnt lgkmcnt(0)
  s_barrier
  s_cmp_lg_u32 s28, 0
  s_cbranch_scc1 sequential_preLN__softmax_full_mha__glu_gated_reglu__prompt_kernel_nomx44
  s_lshl_b32 s30, s27, 8
  s_lshl_b32 s31, s29, 5
  s_add_u32 s30, s30, s31
  s_add_u32 s30, s30, 25690112
  v_lshrrev_b32 v5, 3, v2
  v_lshlrev_b32 v5, 2, v5
  s_mov_b32 exec_lo, 0x01010101
  s_mov_b32 exec_hi, 0x01010101
  buffer_store_dword v28, v5, s[20:23], s30 offen sc1
  buffer_store_dword v30, v5, s[20:23], s30 offen offset:128 sc1
  s_mov_b64 exec, -1
sequential_preLN__softmax_full_mha__glu_gated_reglu__prompt_kernel_nomx44:
  s_mov_b32 s56, 0
  s_cmp_lg_u32 s26, 8
  s_cbranch_scc1 sequential_preLN__softmax_full_mha__glu_gated_reglu__prompt_kernel_nrw45
  s_cmp_eq_u32 s3, 1
  s_cbranch_scc1 sequential_preLN__softmax_full_mha__glu_gated_reglu__prompt_kernel_gatex47
  s_mov_b32 s41, 0
  v_lshlrev_b32 v9, 5, v2
  s_mov_b64 exec, 0xff
sequential_preLN__softmax_full_mha__glu_gated_reglu__prompt_kernel_gate46:
  global_load_dwordx2 v[10:11], v9, s[60:61] offset:16 sc1
  s_add_u32 s41, s41, 1
  s_mov_b64 s[30:31], 0
  s_waitcnt vmcnt(0)
  v_bfe_u32 v12, v10, 0, 8
  v_bfe_u32 v13, v11, 0, 1
  v_bcnt_u32_b32 v12, v12, v13
  v_cmp_ne_u32 vcc, 8, v12
  s_or_b64 s[30:31], s[30:31], vcc
  v_bfe_u32 v12, v10, 8, 8
  v_bfe_u32 v13, v11, 1, 1
  v_bcnt_u32_b32 v12, v12, v13
  v_cmp_ne_u32 vcc, 8, v12
  s_or_b64 s[30:31], s[30:31], vcc
  v_bfe_u32 v12, v10, 16, 8
  v_bfe_u32 v13, v11, 2, 1
  v_bcnt_u32_b32 v12, v12, v13
  v_cmp_ne_u32 vcc, 8, v12
  s_or_b64 s[30:31], s[30:31], vcc
  v_bfe_u32 v12, v10, 24, 8
  v_bfe_u32 v13, v11, 3, 1
  v_bcnt_u32_b32 v12, v12, v13
  v_cmp_ne_u32 vcc, 8, v12
  s_or_b64 s[30:31], s[30:31], vcc
  s_cbranch_scc0 sequential_preLN__softmax_full_mha__glu_gated_reglu__prompt_kernel_gate248
  s_sleep 8
  s_cmp_lt_u32 s41, 0x4000
  s_cbranch_scc1 sequential_preLN__softmax_full_mha__glu_gated_reglu__prompt_kernel_gate46
  s_mov_b32 s56, 1
  s_branch sequential_preLN__softmax_full_mha__glu_gated_reglu__prompt_kernel_gatex47
sequential_preLN__softmax_full_mha__glu_gated_reglu__prompt_kernel_gate248:
  s_cmp_lt_u32 s1, 8
  s_cbranch_scc1 sequential_preLN__softmax_full_mha__glu_gated_reglu__prompt_kernel_gatex47
  v_readlane_b32 s30, v10, s24
  s_and_b32 s31, s25, 24
  s_lshr_b32 s30, s30, s31
  s_ff0_i32_b32 s30, s30
  s_add_u32 s30, s30, s31
  s_cmp_eq_u32 s30, s25
  s_cbranch_scc1 sequential_preLN__softmax_full_mha__glu_gated_reglu__prompt_kernel_gatex47
  s_or_b32 s56, s30, 0x100
sequential_preLN__softmax_full_mha__glu_gated_reglu__prompt_kernel_gatex47:
  s_mov_b64 exec, -1
  v_mov_b32 v4, 163832
  v_mov_b32 v5, s56
  ds_write_b32 v4, v5
  s_waitcnt lgkmcnt(0)
sequential_preLN__softmax_full_mha__glu_gated_reglu__prompt_kernel_nrw45:
  s_lshl_b32 s40, s28, 5
  s_add_u32 s40, s40, s27
  s_lshl_b32 s40, s40, 7
  s_add_u32 s40, s40, 26279936
  v_mov_b32 v8, 1
  v_mov_b32 v9, 0
  s_and_b32 s59, s3, 1
  s_xor_b32 s59, s59, 1
  s_waitcnt vmcnt(0)
  s_barrier
  s_cmp_lg_u32 s26, 8
  s_cbranch_scc1 sequential_preLN__softmax_full_mha__glu_gated_reglu__prompt_kernel_RL17
  s_cmp_lg_u32 s56, 0
  s_cbranch_scc1 sequential_preLN__softmax_full_mha__glu_gated_reglu__prompt_kernel_nofire49
  s_mov_b64 exec, 1
  s_cmp_eq_u32 s59, 1
  s_cbranch_scc1 sequential_preLN__softmax_full_mha__glu_gated_reglu__prompt_kernel_ps50
  buffer_store_dword v8, v9, s[20:23], s40 offen sc1
  s_branch sequential_preLN__softmax_full_mha__glu_gated_reglu__prompt_kernel_pe51
sequential_preLN__softmax_full_mha__glu_gated_reglu__prompt_kernel_ps50:
  buffer_store_dword v8, v9, s[20:23], s40 offen
sequential_preLN__softmax_full_mha__glu_gated_reglu__prompt_kernel_pe51:
  s_mov_b64 exec, -1
sequential_preLN__softmax_full_mha__glu_gated_reglu__prompt_kernel_nofire49:
  v_mov_b32 v1, 163832
  ds_read_b32 v1, v1
  s_waitcnt lgkmcnt(0)
  v_readfirstlane_b32 s0, v1
  s_nop 0
  s_cmp_eq_u32 s0, 0
  s_cbranch_scc1 sequential_preLN__softmax_full_mha__glu_gated_reglu__prompt_kernel_rok52
  s_branch sequential_preLN__softmax_full_mha__glu_gated_reglu__prompt_kernel_redo
sequential_preLN__softmax_full_mha__glu_gated_reglu__prompt_kernel_rok52:
  s_lshl_b32 s62, s24, 2
  s_and_b32 s63, s25, 3
  s_add_u32 s62, s62, s63
  s_lshr_b32 s63, s25, 2
  v_mov_b32 v4, 131072
  v_mov_b32 v5, 0
  ds_write_b32 v4, v5 offset:0
  ds_write_b32 v4, v5 offset:16
  ds_write_b32 v4, v5 offset:20
  ds_write_b32 v4, v5 offset:32
  ds_write_b32 v4, v5 offset:48
  s_lshr_b32 s42, s62, 2
  s_lshl_b32 s42, s42, 5
  s_lshl_b32 s40, s42, 7
  s_add_u32 s40, s40, 26279936
  s_mov_b32 exec_lo, 0xffffffff
  s_mov_b32 exec_hi, 0
  v_lshlrev_b32 v9, 7, v2
  s_mov_b32 s41, 0
sequential_preLN__softmax_full_mha__glu_gated_reglu__prompt_kernel_poll53:
  buffer_load_dword v10, v9, s[20:23], s40 offen sc1
  s_add_u32 s41, s41, 1
  s_cmp_gt_u32 s41, 0x40000
  s_cbranch_scc1 sequential_preLN__softmax_full_mha__glu_gated_reglu__prompt_kernel_pollx54
  s_waitcnt vmcnt(0)
  v_cmp_gt_u32 vcc, 1, v10
  s_cmp_eq_u64 vcc, 0
  s_cbranch_scc1 sequential_preLN__softmax_full_mha__glu_gated_reglu__prompt_kernel_pollx54
  s_sleep 2
  s_branch sequential_preLN__softmax_full_mha__glu_gated_reglu__prompt_kernel_poll53
sequential_preLN__softmax_full_mha__glu_gated_reglu__prompt_kernel_pollx54:
  s_waitcnt vmcnt(0)
  s_mov_b64 exec, -1
  s_branch sequential_preLN__softmax_full_mha__glu_gated_reglu__prompt_kernel_H255
sequential_preLN__softmax_full_mha__glu_gated_reglu__prompt_kernel_C5:
  s_setprio 1
  s_and_b32 s59, s3, 1
  s_xor_b32 s59, s59, 1
  v_and_b32 v8, 31, v2
  v_lshrrev_b32 v4, 5, v2
  v_lshrrev_b32 v5, 1, v8
  v_and_b32 v5, 7, v5
  s_and_b32 s34, s26, 1
  s_lshl_b32 s35, s34, 12
  v_lshlrev_b32 v6, 7, v8
  v_add_u32 v6, s35, v6
  v_add_u32 v7, 0, v4
  v_xor_b32 v7, v7, v5
  v_lshl_add_u32 v12, v7, 4, v6
  v_add_u32 v7, 2, v4
  v_xor_b32 v7, v7, v5
  v_lshl_add_u32 v13, v7, 4, v6
  v_add_u32 v7, 4, v4
  v_xor_b32 v7, v7, v5
  v_lshl_add_u32 v14, v7, 4, v6
  v_add_u32 v7, 6, v4
  v_xor_b32 v7, v7, v5
  v_lshl_add_u32 v15, v7, 4, v6
  s_lshr_b32 s36, s26, 1
  v_bfe_u32 v5, v2, 2, 2
  v_lshl_add_u32 v6, v4, 3, v5
  v_lshlrev_b32 v6, 7, v6
  v_bfe_u32 v7, v2, 4, 1
  v_lshlrev_b32 v7, 1, v7
  v_bfe_u32 v11, v2, 1, 1
  v_add_u32 v7, v7, v11
  s_lshl_b32 s37, s36, 2
  v_add_u32 v7, s37, v7
  v_lshlrev_b32 v5, 1, v5
  v_xor_b32 v7, v7, v5
  v_lshl_add_u32 v6, v7, 4, v6
  v_and_b32 v7, 1, v2
  v_lshl_add_u32 v17, v7, 3, v6
  v_add_u32 v17, 0x10000, v17
  v_mov_b32 v16, v17
  v_and_b32 v5, 15, v2
  v_bfe_u32 v7, v2, 4, 1
  v_cmp_eq_u32 vcc, v5, v7
  v_mov_b32 v6, 0x3f803f80
  s_mov_b32 s47, 0
  v_cndmask_b32 v144, 0, v6, vcc
  v_mov_b32 v145, v144
  v_mov_b32 v146, v144
  v_mov_b32 v147, v144
  v_mov_b32 v84, 0
  v_mov_b32 v85, 0
  v_mov_b32 v86, 0
  v_mov_b32 v87, 0
  v_mov_b32 v88, 0
  v_mov_b32 v89, 0
  v_mov_b32 v90, 0
  v_mov_b32 v91, 0
  v_mov_b32 v92, 0
  v_mov_b32 v93, 0
  v_mov_b32 v94, 0
  v_mov_b32 v95, 0
  v_mov_b32 v96, 0
  v_mov_b32 v97, 0
  v_mov_b32 v98, 0
  v_mov_b32 v99, 0
  v_mov_b32 v100, 0
  v_mov_b32 v101, 0
  v_mov_b32 v102, 0
  v_mov_b32 v103, 0
  v_mov_b32 v104, 0
  v_mov_b32 v105, 0
  v_mov_b32 v106, 0
  v_mov_b32 v107, 0
  v_mov_b32 v108, 0
  v_mov_b32 v109, 0
  v_mov_b32 v110, 0
  v_mov_b32 v111, 0
  v_mov_b32 v112, 0
  v_mov_b32 v113, 0
  v_mov_b32 v114, 0
  v_mov_b32 v115, 0
  v_mov_b32 v116, 0
  v_mov_b32 v117, 0
  v_mov_b32 v118, 0
  v_mov_b32 v119, 0
  v_mov_b32 v120, 0
  v_mov_b32 v121, 0
  v_mov_b32 v122, 0
  v_mov_b32 v123, 0
  v_mov_b32 v124, 0
  v_mov_b32 v125, 0
  v_mov_b32 v126, 0
  v_mov_b32 v127, 0
  v_mov_b32 v128, 0
  v_mov_b32 v129, 0
  v_mov_b32 v130, 0
  v_mov_b32 v131, 0
  v_mov_b32 v132, 0
  v_mov_b32 v133, 0
  v_mov_b32 v134, 0
  v_mov_b32 v135, 0
  v_mov_b32 v136, 0
  v_mov_b32 v137, 0
  v_mov_b32 v138, 0
  v_mov_b32 v139, 0
  v_mov_b32 v140, 0
  v_mov_b32 v141, 0
  v_mov_b32 v142, 0
  v_mov_b32 v143, 0
  s_lshl_b32 s40, s28, 2
  s_lshl_b32 s41, s36, 1
  s_add_u32 s40, s40, s41
  s_lshl_b32 s40, s40, 16
  s_lshl_b32 s41, s27, 1
  s_add_u32 s41, s41, s34
  s_lshl_b32 s41, s41, 10
  s_add_u32 s40, s40, s41
  v_bfe_u32 v9, v2, 4, 1
  v_lshlrev_b32 v9, 16, v9
  v_lshl_add_u32 v9, v4, 8, v9
  v_lshl_add_u32 v9, v5, 4, v9
  s_add_u32 s43, s40, 65536
  s_add_u32 s44, s40, 2097152
  s_add_u32 s45, s40, 2162688
  s_add_u32 s46, s40, 4194304
  s_mov_b32 s48, 0
  s_lshl_b32 s35, s34, 1
  s_add_u32 s35, s35, s36
  s_mul_i32 s35, s35, 384
  s_add_u32 s35, s35, 102400
  v_lshl_add_u32 v5, v2, 2, s35
  s_mul_i32 s37, s36, 384
  s_add_u32 s37, s37, 102400
  v_lshl_add_u32 v6, v4, 4, s37
  v_lshl_add_u32 v7, v8, 2, s37
  s_lshl_b32 s38, s34, 7
  s_add_u32 s38, s38, 90112
  v_lshl_add_u32 v10, v8, 2, s38
  v_lshl_add_u32 v11, v4, 4, s38
  s_waitcnt lgkmcnt(0)
  s_mov_b32 s20, s62
  s_and_b32 s21, s63, 0xffff
  s_mov_b32 s22, 33554432
  s_mov_b32 s23, 0x20000
  s_barrier
  s_cmp_eq_u32 s49, 1
  s_cbranch_scc1 sequential_preLN__softmax_full_mha__glu_gated_reglu__prompt_kernel_ec56
sequential_preLN__softmax_full_mha__glu_gated_reglu__prompt_kernel_ecb57:
  ds_read_b128 v[68:71], v12
  ds_read_b64_tr_b16 v[20:21], v16 offset:0
  ds_read_b64_tr_b16 v[22:23], v16 offset:512
  ds_read_b64_tr_b16 v[24:25], v16 offset:4096
  ds_read_b64_tr_b16 v[26:27], v16 offset:4608
  ds_read_b64_tr_b16 v[28:29], v16 offset:8192
  ds_read_b64_tr_b16 v[30:31], v16 offset:8704
  ds_read_b128 v[72:75], v13
  ds_read_b64_tr_b16 v[32:33], v16 offset:2048
  ds_read_b64_tr_b16 v[34:35], v16 offset:2560
  ds_read_b64_tr_b16 v[36:37], v16 offset:6144
  ds_read_b64_tr_b16 v[38:39], v16 offset:6656
  ds_read_b64_tr_b16 v[40:41], v16 offset:10240
  ds_read_b64_tr_b16 v[42:43], v16 offset:10752
  s_cmp_eq_u32 s34, 1
  s_cbranch_scc1 sequential_preLN__softmax_full_mha__glu_gated_reglu__prompt_kernel_p1odd58
  .p2align 3
sequential_preLN__softmax_full_mha__glu_gated_reglu__prompt_kernel_p1ml60:
  s_waitcnt lgkmcnt(7)
  v_mfma_f32_32x32x16_bf16 v[84:99], v[20:23], v[68:71], v[84:99]
  ds_read_b128 v[76:79], v14
  ds_read_b64_tr_b16 v[44:45], v16 offset:12288
  ds_read_b64_tr_b16 v[46:47], v16 offset:12800
  v_mfma_f32_16x16x32_bf16 v[132:135], v[144:147], v[20:23], v[132:135]
  v_mfma_f32_32x32x16_bf16 v[100:115], v[24:27], v[68:71], v[100:115]
  ds_read_b64_tr_b16 v[48:49], v16 offset:16384
  ds_read_b64_tr_b16 v[50:51], v16 offset:16896
  v_mfma_f32_16x16x32_bf16 v[136:139], v[144:147], v[24:27], v[136:139]
  v_mfma_f32_32x32x16_bf16 v[116:131], v[68:71], v[28:31], v[116:131]
  ds_read_b64_tr_b16 v[52:53], v16 offset:20480
  ds_read_b64_tr_b16 v[54:55], v16 offset:20992
  v_mfma_f32_16x16x32_bf16 v[140:143], v[144:147], v[28:31], v[140:143]
  s_waitcnt lgkmcnt(7)
  v_mfma_f32_32x32x16_bf16 v[84:99], v[32:35], v[72:75], v[84:99]
  ds_read_b128 v[80:83], v15
  ds_read_b64_tr_b16 v[56:57], v16 offset:14336
  ds_read_b64_tr_b16 v[58:59], v16 offset:14848
  v_mfma_f32_32x32x16_bf16 v[100:115], v[36:39], v[72:75], v[100:115]
  ds_read_b64_tr_b16 v[60:61], v16 offset:18432
  ds_read_b64_tr_b16 v[62:63], v16 offset:18944
  v_mfma_f32_32x32x16_bf16 v[116:131], v[72:75], v[40:43], v[116:131]
  ds_read_b64_tr_b16 v[64:65], v16 offset:22528
  ds_read_b64_tr_b16 v[66:67], v16 offset:23040
  s_add_u32 s48, s48, 24576
  s_cmp_eq_u32 s48, 98304
  s_cselect_b32 s48, 0, s48
  v_add_u32 v12, 8192, v12
  v_add_u32 v13, 8192, v13
  s_barrier
  s_cmp_eq_u32 s49, 1
  s_cbranch_scc1 sequential_preLN__softmax_full_mha__glu_gated_reglu__prompt_kernel_ec61
sequential_preLN__softmax_full_mha__glu_gated_reglu__prompt_kernel_ecb62:
  v_add_u32 v16, s48, v17
  s_waitcnt lgkmcnt(7)
  v_mfma_f32_32x32x16_bf16 v[84:99], v[44:47], v[76:79], v[84:99]
  ds_read_b128 v[68:71], v12
  ds_read_b64_tr_b16 v[20:21], v16 offset:0
  ds_read_b64_tr_b16 v[22:23], v16 offset:512
  v_mfma_f32_16x16x32_bf16 v[132:135], v[144:147], v[44:47], v[132:135]
  v_mfma_f32_32x32x16_bf16 v[100:115], v[48:51], v[76:79], v[100:115]
  ds_read_b64_tr_b16 v[24:25], v16 offset:4096
  ds_read_b64_tr_b16 v[26:27], v16 offset:4608
  v_mfma_f32_16x16x32_bf16 v[136:139], v[144:147], v[48:51], v[136:139]
  v_mfma_f32_32x32x16_bf16 v[116:131], v[76:79], v[52:55], v[116:131]
  ds_read_b64_tr_b16 v[28:29], v16 offset:8192
  ds_read_b64_tr_b16 v[30:31], v16 offset:8704
  v_mfma_f32_16x16x32_bf16 v[140:143], v[144:147], v[52:55], v[140:143]
  s_waitcnt lgkmcnt(7)
  v_mfma_f32_32x32x16_bf16 v[84:99], v[56:59], v[80:83], v[84:99]
  ds_read_b128 v[72:75], v13
  ds_read_b64_tr_b16 v[32:33], v16 offset:2048
  ds_read_b64_tr_b16 v[34:35], v16 offset:2560
  v_mfma_f32_32x32x16_bf16 v[100:115], v[60:63], v[80:83], v[100:115]
  ds_read_b64_tr_b16 v[36:37], v16 offset:6144
  ds_read_b64_tr_b16 v[38:39], v16 offset:6656
  v_mfma_f32_32x32x16_bf16 v[116:131], v[80:83], v[64:67], v[116:131]
  ds_read_b64_tr_b16 v[40:41], v16 offset:10240
  ds_read_b64_tr_b16 v[42:43], v16 offset:10752
  v_add_u32 v14, 8192, v14
  v_add_u32 v15, 8192, v15
  s_add_u32 s47, s47, 1
  s_cmp_lt_u32 s47, 7
  s_cbranch_scc1 sequential_preLN__softmax_full_mha__glu_gated_reglu__prompt_kernel_p1ml60
  s_waitcnt lgkmcnt(7)
  v_mfma_f32_32x32x16_bf16 v[84:99], v[20:23], v[68:71], v[84:99]
  ds_read_b128 v[76:79], v14
  ds_read_b64_tr_b16 v[44:45], v16 offset:12288
  ds_read_b64_tr_b16 v[46:47], v16 offset:12800
  v_mfma_f32_16x16x32_bf16 v[132:135], v[144:147], v[20:23], v[132:135]
  v_mfma_f32_32x32x16_bf16 v[100:115], v[24:27], v[68:71], v[100:115]
  ds_read_b64_tr_b16 v[48:49], v16 offset:16384
  ds_read_b64_tr_b16 v[50:51], v16 offset:16896
  v_mfma_f32_16x16x32_bf16 v[136:139], v[144:147], v[24:27], v[136:139]
  v_mfma_f32_32x32x16_bf16 v[116:131], v[68:71], v[28:31], v[116:131]
  ds_read_b64_tr_b16 v[52:53], v16 offset:20480
  ds_read_b64_tr_b16 v[54:55], v16 offset:20992
  v_mfma_f32_16x16x32_bf16 v[140:143], v[144:147], v[28:31], v[140:143]
  s_waitcnt lgkmcnt(7)
  v_mfma_f32_32x32x16_bf16 v[84:99], v[32:35], v[72:75], v[84:99]
  ds_read_b128 v[80:83], v15
  ds_read_b64_tr_b16 v[56:57], v16 offset:14336
  ds_read_b64_tr_b16 v[58:59], v16 offset:14848
  v_mfma_f32_32x32x16_bf16 v[100:115], v[36:39], v[72:75], v[100:115]
  ds_read_b64_tr_b16 v[60:61], v16 offset:18432
  ds_read_b64_tr_b16 v[62:63], v16 offset:18944
  v_mfma_f32_32x32x16_bf16 v[116:131], v[72:75], v[40:43], v[116:131]
  ds_read_b64_tr_b16 v[64:65], v16 offset:22528
  ds_read_b64_tr_b16 v[66:67], v16 offset:23040
  s_waitcnt lgkmcnt(7)
  v_mfma_f32_16x16x32_bf16 v[132:135], v[144:147], v[44:47], v[132:135]
  v_mfma_f32_16x16x32_bf16 v[136:139], v[144:147], v[48:51], v[136:139]
  v_mfma_f32_16x16x32_bf16 v[140:143], v[144:147], v[52:55], v[140:143]
  s_branch sequential_preLN__softmax_full_mha__glu_gated_reglu__prompt_kernel_p1ep59
sequential_preLN__softmax_full_mha__glu_gated_reglu__prompt_kernel_p1odd58:
  .p2align 3
sequential_preLN__softmax_full_mha__glu_gated_reglu__prompt_kernel_p1ml63:
  s_waitcnt lgkmcnt(7)
  v_mfma_f32_32x32x16_bf16 v[84:99], v[20:23], v[68:71], v[84:99]
  ds_read_b128 v[76:79], v14
  ds_read_b64_tr_b16 v[44:45], v16 offset:12288
  ds_read_b64_tr_b16 v[46:47], v16 offset:12800
  v_mfma_f32_32x32x16_bf16 v[100:115], v[24:27], v[68:71], v[100:115]
  ds_read_b64_tr_b16 v[48:49], v16 offset:16384
  ds_read_b64_tr_b16 v[50:51], v16 offset:16896
  v_mfma_f32_32x32x16_bf16 v[116:131], v[68:71], v[28:31], v[116:131]
  ds_read_b64_tr_b16 v[52:53], v16 offset:20480
  ds_read_b64_tr_b16 v[54:55], v16 offset:20992
  s_waitcnt lgkmcnt(7)
  v_mfma_f32_32x32x16_bf16 v[84:99], v[32:35], v[72:75], v[84:99]
  ds_read_b128 v[80:83], v15
  ds_read_b64_tr_b16 v[56:57], v16 offset:14336
  ds_read_b64_tr_b16 v[58:59], v16 offset:14848
  v_mfma_f32_16x16x32_bf16 v[132:135], v[144:147], v[32:35], v[132:135]
  v_mfma_f32_32x32x16_bf16 v[100:115], v[36:39], v[72:75], v[100:115]
  ds_read_b64_tr_b16 v[60:61], v16 offset:18432
  ds_read_b64_tr_b16 v[62:63], v16 offset:18944
  v_mfma_f32_16x16x32_bf16 v[136:139], v[144:147], v[36:39], v[136:139]
  v_mfma_f32_32x32x16_bf16 v[116:131], v[72:75], v[40:43], v[116:131]
  ds_read_b64_tr_b16 v[64:65], v16 offset:22528
  ds_read_b64_tr_b16 v[66:67], v16 offset:23040
  v_mfma_f32_16x16x32_bf16 v[140:143], v[144:147], v[40:43], v[140:143]
  s_add_u32 s48, s48, 24576
  s_cmp_eq_u32 s48, 98304
  s_cselect_b32 s48, 0, s48
  v_add_u32 v12, 8192, v12
  v_add_u32 v13, 8192, v13
  s_barrier
  s_cmp_eq_u32 s49, 1
  s_cbranch_scc1 sequential_preLN__softmax_full_mha__glu_gated_reglu__prompt_kernel_ec64
sequential_preLN__softmax_full_mha__glu_gated_reglu__prompt_kernel_ecb65:
  v_add_u32 v16, s48, v17
  s_waitcnt lgkmcnt(7)
  v_mfma_f32_32x32x16_bf16 v[84:99], v[44:47], v[76:79], v[84:99]
  ds_read_b128 v[68:71], v12
  ds_read_b64_tr_b16 v[20:21], v16 offset:0
  ds_read_b64_tr_b16 v[22:23], v16 offset:512
  v_mfma_f32_32x32x16_bf16 v[100:115], v[48:51], v[76:79], v[100:115]
  ds_read_b64_tr_b16 v[24:25], v16 offset:4096
  ds_read_b64_tr_b16 v[26:27], v16 offset:4608
  v_mfma_f32_32x32x16_bf16 v[116:131], v[76:79], v[52:55], v[116:131]
  ds_read_b64_tr_b16 v[28:29], v16 offset:8192
  ds_read_b64_tr_b16 v[30:31], v16 offset:8704
  s_waitcnt lgkmcnt(7)
  v_mfma_f32_32x32x16_bf16 v[84:99], v[56:59], v[80:83], v[84:99]
  ds_read_b128 v[72:75], v13
  ds_read_b64_tr_b16 v[32:33], v16 offset:2048
  ds_read_b64_tr_b16 v[34:35], v16 offset:2560
  v_mfma_f32_16x16x32_bf16 v[132:135], v[144:147], v[56:59], v[132:135]
  v_mfma_f32_32x32x16_bf16 v[100:115], v[60:63], v[80:83], v[100:115]
  ds_read_b64_tr_b16 v[36:37], v16 offset:6144
  ds_read_b64_tr_b16 v[38:39], v16 offset:6656
  v_mfma_f32_16x16x32_bf16 v[136:139], v[144:147], v[60:63], v[136:139]
  v_mfma_f32_32x32x16_bf16 v[116:131], v[80:83], v[64:67], v[116:131]
  ds_read_b64_tr_b16 v[40:41], v16 offset:10240
  ds_read_b64_tr_b16 v[42:43], v16 offset:10752
  v_mfma_f32_16x16x32_bf16 v[140:143], v[144:147], v[64:67], v[140:143]
  v_add_u32 v14, 8192, v14
  v_add_u32 v15, 8192, v15
  s_add_u32 s47, s47, 1
  s_cmp_lt_u32 s47, 7
  s_cbranch_scc1 sequential_preLN__softmax_full_mha__glu_gated_reglu__prompt_kernel_p1ml63
  s_waitcnt lgkmcnt(7)
  v_mfma_f32_32x32x16_bf16 v[84:99], v[20:23], v[68:71], v[84:99]
  ds_read_b128 v[76:79], v14
  ds_read_b64_tr_b16 v[44:45], v16 offset:12288
  ds_read_b64_tr_b16 v[46:47], v16 offset:12800
  v_mfma_f32_32x32x16_bf16 v[100:115], v[24:27], v[68:71], v[100:115]
  ds_read_b64_tr_b16 v[48:49], v16 offset:16384
  ds_read_b64_tr_b16 v[50:51], v16 offset:16896
  v_mfma_f32_32x32x16_bf16 v[116:131], v[68:71], v[28:31], v[116:131]
  ds_read_b64_tr_b16 v[52:53], v16 offset:20480
  ds_read_b64_tr_b16 v[54:55], v16 offset:20992
  s_waitcnt lgkmcnt(7)
  v_mfma_f32_32x32x16_bf16 v[84:99], v[32:35], v[72:75], v[84:99]
  ds_read_b128 v[80:83], v15
  ds_read_b64_tr_b16 v[56:57], v16 offset:14336
  ds_read_b64_tr_b16 v[58:59], v16 offset:14848
  v_mfma_f32_16x16x32_bf16 v[132:135], v[144:147], v[32:35], v[132:135]
  v_mfma_f32_32x32x16_bf16 v[100:115], v[36:39], v[72:75], v[100:115]
  ds_read_b64_tr_b16 v[60:61], v16 offset:18432
  ds_read_b64_tr_b16 v[62:63], v16 offset:18944
  v_mfma_f32_16x16x32_bf16 v[136:139], v[144:147], v[36:39], v[136:139]
  v_mfma_f32_32x32x16_bf16 v[116:131], v[72:75], v[40:43], v[116:131]
  ds_read_b64_tr_b16 v[64:65], v16 offset:22528
  ds_read_b64_tr_b16 v[66:67], v16 offset:23040
  v_mfma_f32_16x16x32_bf16 v[140:143], v[144:147], v[40:43], v[140:143]
  s_waitcnt lgkmcnt(0)
  v_mfma_f32_16x16x32_bf16 v[132:135], v[144:147], v[56:59], v[132:135]
  v_mfma_f32_16x16x32_bf16 v[136:139], v[144:147], v[60:63], v[136:139]
  v_mfma_f32_16x16x32_bf16 v[140:143], v[144:147], v[64:67], v[140:143]
sequential_preLN__softmax_full_mha__glu_gated_reglu__prompt_kernel_p1ep59:
  s_waitcnt lgkmcnt(0)
  v_mfma_f32_32x32x16_bf16 v[84:99], v[44:47], v[76:79], v[84:99]
  v_mfma_f32_32x32x16_bf16 v[84:99], v[56:59], v[80:83], v[84:99]
  s_mov_b32 s42, 0x3eb8aa3b
  s_nop 2
  s_mov_b64 exec, 0xffff
  ds_write2_b32 v5, v132, v133 offset0:0 offset1:16
  ds_write2_b32 v5, v136, v137 offset0:32 offset1:48
  ds_write2_b32 v5, v140, v141 offset0:64 offset1:80
  s_mov_b64 exec, -1
  v_mfma_f32_32x32x16_bf16 v[100:115], v[48:51], v[76:79], v[100:115]
  s_waitcnt lgkmcnt(0)
  s_barrier
  ds_read_b32 v132, v10
  ds_read_b32 v134, v10 offset:256
  v_mfma_f32_32x32x16_bf16 v[100:115], v[60:63], v[80:83], v[100:115]
  ds_read_b128 v[20:23], v6 offset:0
  ds_read_b128 v[36:39], v6 offset:768
  ds_read_b128 v[24:27], v6 offset:32
  ds_read_b128 v[40:43], v6 offset:800
  ds_read_b128 v[28:31], v6 offset:64
  ds_read_b128 v[68:71], v6 offset:832
  ds_read_b128 v[32:35], v6 offset:96
  ds_read_b128 v[72:75], v6 offset:864
  v_mfma_f32_32x32x16_bf16 v[116:131], v[76:79], v[52:55], v[116:131]
  ds_read_b32 v136, v7 offset:256
  ds_read_b32 v137, v7 offset:1024
  s_waitcnt lgkmcnt(10)
  v_mul_f32 v138, s42, v132
  v_mul_f32 v140, s42, v134
  v_mfma_f32_32x32x16_bf16 v[116:131], v[80:83], v[64:67], v[116:131]
  s_waitcnt lgkmcnt(2)
  v_pk_add_f32 v[20:21], v[20:21], v[36:37]
  v_pk_add_f32 v[22:23], v[22:23], v[38:39]
  v_pk_add_f32 v[24:25], v[24:25], v[40:41]
  v_pk_add_f32 v[26:27], v[26:27], v[42:43]
  v_pk_add_f32 v[28:29], v[28:29], v[68:69]
  v_pk_add_f32 v[30:31], v[30:31], v[70:71]
  v_pk_add_f32 v[32:33], v[32:33], v[72:73]
  v_pk_add_f32 v[34:35], v[34:35], v[74:75]
  v_pk_mul_f32 v[20:21], v[20:21], v[140:141] op_sel_hi:[1,0]
  v_pk_mul_f32 v[22:23], v[22:23], v[140:141] op_sel_hi:[1,0]
  v_pk_mul_f32 v[24:25], v[24:25], v[140:141] op_sel_hi:[1,0]
  v_pk_mul_f32 v[26:27], v[26:27], v[140:141] op_sel_hi:[1,0]
  v_pk_mul_f32 v[28:29], v[28:29], v[140:141] op_sel_hi:[1,0]
  v_pk_mul_f32 v[30:31], v[30:31], v[140:141] op_sel_hi:[1,0]
  v_pk_mul_f32 v[32:33], v[32:33], v[140:141] op_sel_hi:[1,0]
  v_pk_mul_f32 v[34:35], v[34:35], v[140:141] op_sel_hi:[1,0]
  v_pk_fma_f32 v[84:85], v[84:85], v[138:139], v[20:21] op_sel_hi:[1,0,1]
  v_pk_fma_f32 v[86:87], v[86:87], v[138:139], v[22:23] op_sel_hi:[1,0,1]
  v_pk_fma_f32 v[88:89], v[88:89], v[138:139], v[24:25] op_sel_hi:[1,0,1]
  v_pk_fma_f32 v[90:91], v[90:91], v[138:139], v[26:27] op_sel_hi:[1,0,1]
  v_pk_fma_f32 v[92:93], v[92:93], v[138:139], v[28:29] op_sel_hi:[1,0,1]
  v_pk_fma_f32 v[94:95], v[94:95], v[138:139], v[30:31] op_sel_hi:[1,0,1]
  v_pk_fma_f32 v[96:97], v[96:97], v[138:139], v[32:33] op_sel_hi:[1,0,1]
  v_pk_fma_f32 v[98:99], v[98:99], v[138:139], v[34:35] op_sel_hi:[1,0,1]
  ds_read_b128 v[20:23], v6 offset:128
  ds_read_b128 v[36:39], v6 offset:896
  ds_read_b128 v[24:27], v6 offset:160
  ds_read_b128 v[40:43], v6 offset:928
  ds_read_b128 v[28:31], v6 offset:192
  ds_read_b128 v[68:71], v6 offset:960
  ds_read_b128 v[32:35], v6 offset:224
  ds_read_b128 v[72:75], v6 offset:992
  ds_read_b128 v[44:47], v11 offset:0
  ds_read_b128 v[48:51], v11 offset:32
  ds_read_b128 v[52:55], v11 offset:64
  ds_read_b128 v[56:59], v11 offset:96
  v_cvt_pk_bf16_f32 v144, v84, v85
  v_cvt_pk_bf16_f32 v145, v86, v87
  v_cvt_pk_bf16_f32 v146, v88, v89
  v_cvt_pk_bf16_f32 v147, v90, v91
  buffer_store_dwordx4 v[144:147], v3, s[20:23], s40 offen sc1
  v_cvt_pk_bf16_f32 v148, v92, v93
  v_cvt_pk_bf16_f32 v149, v94, v95
  v_cvt_pk_bf16_f32 v150, v96, v97
  v_cvt_pk_bf16_f32 v151, v98, v99
  buffer_store_dwordx4 v[148:151], v3, s[20:23], s43 offen sc1
  s_waitcnt lgkmcnt(4)
  v_pk_add_f32 v[20:21], v[20:21], v[36:37]
  v_pk_add_f32 v[22:23], v[22:23], v[38:39]
  v_pk_add_f32 v[24:25], v[24:25], v[40:41]
  v_pk_add_f32 v[26:27], v[26:27], v[42:43]
  v_pk_add_f32 v[28:29], v[28:29], v[68:69]
  v_pk_add_f32 v[30:31], v[30:31], v[70:71]
  v_pk_add_f32 v[32:33], v[32:33], v[72:73]
  v_pk_add_f32 v[34:35], v[34:35], v[74:75]
  v_pk_mul_f32 v[20:21], v[20:21], v[134:135] op_sel_hi:[1,0]
  v_pk_mul_f32 v[22:23], v[22:23], v[134:135] op_sel_hi:[1,0]
  v_pk_mul_f32 v[24:25], v[24:25], v[134:135] op_sel_hi:[1,0]
  v_pk_mul_f32 v[26:27], v[26:27], v[134:135] op_sel_hi:[1,0]
  v_pk_mul_f32 v[28:29], v[28:29], v[134:135] op_sel_hi:[1,0]
  v_pk_mul_f32 v[30:31], v[30:31], v[134:135] op_sel_hi:[1,0]
  v_pk_mul_f32 v[32:33], v[32:33], v[134:135] op_sel_hi:[1,0]
  v_pk_mul_f32 v[34:35], v[34:35], v[134:135] op_sel_hi:[1,0]
  v_pk_fma_f32 v[100:101], v[100:101], v[132:133], v[20:21] op_sel_hi:[1,0,1]
  v_pk_fma_f32 v[102:103], v[102:103], v[132:133], v[22:23] op_sel_hi:[1,0,1]
  v_pk_fma_f32 v[104:105], v[104:105], v[132:133], v[24:25] op_sel_hi:[1,0,1]
  v_pk_fma_f32 v[106:107], v[106:107], v[132:133], v[26:27] op_sel_hi:[1,0,1]
  v_pk_fma_f32 v[108:109], v[108:109], v[132:133], v[28:29] op_sel_hi:[1,0,1]
  v_pk_fma_f32 v[110:111], v[110:111], v[132:133], v[30:31] op_sel_hi:[1,0,1]
  v_pk_fma_f32 v[112:113], v[112:113], v[132:133], v[32:33] op_sel_hi:[1,0,1]
  v_pk_fma_f32 v[114:115], v[114:115], v[132:133], v[34:35] op_sel_hi:[1,0,1]
  ds_read_b128 v[60:63], v11 offset:256
  ds_read_b128 v[64:67], v11 offset:288
  ds_read_b128 v[68:71], v11 offset:320
  ds_read_b128 v[72:75], v11 offset:352
  v_cvt_pk_bf16_f32 v152, v100, v101
  v_cvt_pk_bf16_f32 v153, v102, v103
  v_cvt_pk_bf16_f32 v154, v104, v105
  v_cvt_pk_bf16_f32 v155, v106, v107
  buffer_store_dwordx4 v[152:155], v3, s[20:23], s44 offen sc1
  v_cvt_pk_bf16_f32 v156, v108, v109
  v_cvt_pk_bf16_f32 v157, v110, v111
  v_cvt_pk_bf16_f32 v158, v112, v113
  v_cvt_pk_bf16_f32 v159, v114, v115
  buffer_store_dwordx4 v[156:159], v3, s[20:23], s45 offen sc1
  v_add_f32 v136, v136, v137
  s_waitcnt lgkmcnt(0)
  v_pk_mul_f32 v[60:61], v[60:61], v[136:137] op_sel_hi:[1,0]
  v_pk_mul_f32 v[62:63], v[62:63], v[136:137] op_sel_hi:[1,0]
  v_pk_mul_f32 v[64:65], v[64:65], v[136:137] op_sel_hi:[1,0]
  v_pk_mul_f32 v[66:67], v[66:67], v[136:137] op_sel_hi:[1,0]
  v_pk_mul_f32 v[68:69], v[68:69], v[136:137] op_sel_hi:[1,0]
  v_pk_mul_f32 v[70:71], v[70:71], v[136:137] op_sel_hi:[1,0]
  v_pk_mul_f32 v[72:73], v[72:73], v[136:137] op_sel_hi:[1,0]
  v_pk_mul_f32 v[74:75], v[74:75], v[136:137] op_sel_hi:[1,0]
  v_pk_fma_f32 v[116:117], v[116:117], v[44:45], v[60:61]
  v_pk_fma_f32 v[118:119], v[118:119], v[46:47], v[62:63]
  v_pk_fma_f32 v[120:121], v[120:121], v[48:49], v[64:65]
  v_pk_fma_f32 v[122:123], v[122:123], v[50:51], v[66:67]
  v_pk_fma_f32 v[124:125], v[124:125], v[52:53], v[68:69]
  v_pk_fma_f32 v[126:127], v[126:127], v[54:55], v[70:71]
  v_pk_fma_f32 v[128:129], v[128:129], v[56:57], v[72:73]
  v_pk_fma_f32 v[130:131], v[130:131], v[58:59], v[74:75]
  v_cvt_pk_bf16_f32 v160, v116, v117
  v_cvt_pk_bf16_f32 v161, v118, v119
  v_cvt_pk_bf16_f32 v162, v120, v121
  v_cvt_pk_bf16_f32 v163, v122, v123
  buffer_store_dwordx4 v[160:163], v9, s[20:23], s46 offen sc1
  v_cvt_pk_bf16_f32 v164, v124, v125
  v_cvt_pk_bf16_f32 v165, v126, v127
  v_cvt_pk_bf16_f32 v166, v128, v129
  v_cvt_pk_bf16_f32 v167, v130, v131
  buffer_store_dwordx4 v[164:167], v9, s[20:23], s46 offen offset:512 sc1
  s_waitcnt vmcnt(0)
  s_barrier
  v_mov_b32 v1, 163832
  ds_read_b32 v1, v1
  s_waitcnt lgkmcnt(0)
  v_readfirstlane_b32 s0, v1
  s_nop 0
  s_cmp_eq_u32 s0, 0
  s_cbranch_scc1 sequential_preLN__softmax_full_mha__glu_gated_reglu__prompt_kernel_rok66
  s_branch sequential_preLN__softmax_full_mha__glu_gated_reglu__prompt_kernel_redo
sequential_preLN__softmax_full_mha__glu_gated_reglu__prompt_kernel_rok66:
  s_lshl_b32 s62, s24, 2
  s_and_b32 s63, s25, 3
  s_add_u32 s62, s62, s63
  s_lshr_b32 s63, s25, 2
  s_barrier
sequential_preLN__softmax_full_mha__glu_gated_reglu__prompt_kernel_p24:
  s_lshl_b32 s30, s63, 3
  s_add_u32 s30, s30, s26
  s_lshl_b32 s31, s30, 10
  s_lshl_b32 s29, s62, 16
  s_add_u32 s31, s31, s29
  buffer_load_dwordx4 v[8:11], v3, s[20:23], s31 offen sc1
  v_mov_b32 v4, v3
  v_lshrrev_b32 v6, 5, v2
  v_lshlrev_b32 v6, 8, v6
  v_and_b32 v7, 15, v2
  v_lshl_add_u32 v5, v7, 4, v6
  v_add_u32 v5, 0x10000, v5
  v_and_b32 v6, 27, v2
  v_mov_b32 v7, 0x3f803f80
  v_cmp_eq_u32 vcc, 16, v6
  s_mov_b32 s36, 0xffff
  s_mov_b32 s37, 0xffff
  v_cndmask_b32 v7, 0, v7, vcc
  s_lshl_b32 s42, s30, 15
  s_lshl_b32 s41, s62, 10
  s_add_u32 s42, s42, s41
  s_add_u32 s42, s42, 6291456
  v_mov_b32 v20, v7
  v_mov_b32 v21, v7
  v_mov_b32 v22, v7
  v_mov_b32 v23, v7
  v_mov_b32 v24, v7
  v_mov_b32 v25, v7
  v_mov_b32 v26, v7
  v_mov_b32 v27, v7
  v_mov_b32 v28, v7
  v_mov_b32 v29, v7
  v_mov_b32 v30, v7
  v_mov_b32 v31, v7
  v_mov_b32 v32, v7
  v_mov_b32 v33, v7
  v_mov_b32 v34, v7
  v_mov_b32 v35, v7
  v_mov_b32 v6, 131072
  v_mov_b32 v36, 0
  v_mov_b32 v37, 0
  v_mov_b32 v38, 0
  v_mov_b32 v39, 0
  v_mov_b32 v40, 0
  v_mov_b32 v41, 0
  v_mov_b32 v42, 0
  v_mov_b32 v43, 0
  v_mov_b32 v96, 0
  v_mov_b32 v97, 0
  v_mov_b32 v98, 0
  v_mov_b32 v99, 0
  v_mov_b32 v100, 0
  v_mov_b32 v101, 0
  v_mov_b32 v102, 0
  v_mov_b32 v103, 0
  v_mov_b32 v104, 0
  v_mov_b32 v105, 0
  v_mov_b32 v106, 0
  v_mov_b32 v107, 0
  v_mov_b32 v108, 0
  v_mov_b32 v109, 0
  v_mov_b32 v110, 0
  v_mov_b32 v111, 0
  s_barrier
  ds_read_b128 v[12:15], v4
  ds_read_b128 v[16:19], v4 offset:1024
  s_mov_b64 exec, s[36:37]
  ds_read_b128 v[20:23], v5 offset:0
  ds_read_b128 v[24:27], v5 offset:512
  s_mov_b64 exec, -1
  s_waitcnt vmcnt(0) lgkmcnt(3)
  v_mfma_f32_32x32x16_bf16 v[48:63], v[12:15], v[8:11], 0
  s_nop 11
  v_max3_f32 v44, v48, v49, v50
  v_max3_f32 v45, v51, v52, v53
  v_max3_f32 v44, v44, v54, v55
  v_max3_f32 v45, v45, v56, v57
  v_max3_f32 v44, v44, v58, v59
  v_max3_f32 v45, v45, v60, v61
  v_max3_f32 v44, v44, v62, v63
  v_max_f32 v45, v44, v45
  v_mov_b32 v46, v45
  s_nop 1
  v_permlane32_swap_b32 v45, v46
  s_nop 0
  v_max_f32 v44, v45, v46
  v_sub_f32 v80, 0, v44
  v_sub_f32 v81, 0, v44
  v_sub_f32 v82, 0, v44
  v_sub_f32 v83, 0, v44
  v_sub_f32 v84, 0, v44
  v_sub_f32 v85, 0, v44
  v_sub_f32 v86, 0, v44
  v_sub_f32 v87, 0, v44
  v_sub_f32 v88, 0, v44
  v_sub_f32 v89, 0, v44
  v_sub_f32 v90, 0, v44
  v_sub_f32 v91, 0, v44
  v_sub_f32 v92, 0, v44
  v_sub_f32 v93, 0, v44
  v_sub_f32 v94, 0, v44
  v_sub_f32 v95, 0, v44
  s_nop 1
  v_mfma_f32_32x32x16_bf16 v[48:63], v[12:15], v[8:11], v[80:95]
  s_mov_b32 s38, 0
  s_nop 9
  .p2align 6
sequential_preLN__softmax_full_mha__glu_gated_reglu__prompt_kernel_loop69:
  s_waitcnt lgkmcnt(0)
  v_mfma_f32_32x32x16_bf16 v[64:79], v[16:19], v[8:11], v[80:95]
  s_setprio 0
  ds_read_b128 v[12:15], v4 offset:2048
  v_exp_f32 v48, v48
  v_exp_f32 v49, v49
  v_mfma_f32_32x32x16_bf16 v[96:111], v[32:35], v[40:43], v[96:111]
  s_mov_b64 exec, s[36:37]
  ds_read_b128 v[28:31], v5 offset:1024
  ds_read_b128 v[32:35], v5 offset:1536
  s_mov_b64 exec, -1
  v_exp_f32 v50, v50
  v_exp_f32 v51, v51
  s_setprio 1
  v_cvt_pk_bf16_f32 v36, v48, v49
  v_exp_f32 v52, v52
  v_exp_f32 v53, v53
  v_cvt_pk_bf16_f32 v37, v50, v51
  v_exp_f32 v54, v54
  v_exp_f32 v55, v55
  s_setprio 2
  v_cvt_pk_bf16_f32 v38, v52, v53
  v_exp_f32 v56, v56
  v_exp_f32 v57, v57
  v_cvt_pk_bf16_f32 v39, v54, v55
  v_exp_f32 v58, v58
  v_exp_f32 v59, v59
  v_mfma_f32_32x32x16_bf16 v[96:111], v[20:23], v[36:39], v[96:111]
  v_cvt_pk_bf16_f32 v40, v56, v57
  v_exp_f32 v60, v60
  v_exp_f32 v61, v61
  s_setprio 3
  v_cvt_pk_bf16_f32 v41, v58, v59
  v_exp_f32 v62, v62
  v_exp_f32 v63, v63
  v_cvt_pk_bf16_f32 v42, v60, v61
  v_cvt_pk_bf16_f32 v43, v62, v63
  s_waitcnt lgkmcnt(0)
  v_mfma_f32_32x32x16_bf16 v[48:63], v[12:15], v[8:11], v[80:95]
  s_setprio 0
  ds_read_b128 v[16:19], v4 offset:3072
  v_exp_f32 v64, v64
  v_exp_f32 v65, v65
  v_mfma_f32_32x32x16_bf16 v[96:111], v[24:27], v[40:43], v[96:111]
  s_mov_b64 exec, s[36:37]
  ds_read_b128 v[20:23], v5 offset:2048
  ds_read_b128 v[24:27], v5 offset:2560
  s_mov_b64 exec, -1
  v_exp_f32 v66, v66
  v_exp_f32 v67, v67
  s_setprio 1
  v_cvt_pk_bf16_f32 v36, v64, v65
  v_exp_f32 v68, v68
  v_exp_f32 v69, v69
  v_cvt_pk_bf16_f32 v37, v66, v67
  v_exp_f32 v70, v70
  v_exp_f32 v71, v71
  s_setprio 2
  v_cvt_pk_bf16_f32 v38, v68, v69
  v_exp_f32 v72, v72
  v_exp_f32 v73, v73
  v_cvt_pk_bf16_f32 v39, v70, v71
  v_exp_f32 v74, v74
  v_exp_f32 v75, v75
  v_mfma_f32_32x32x16_bf16 v[96:111], v[28:31], v[36:39], v[96:111]
  v_cvt_pk_bf16_f32 v40, v72, v73
  v_exp_f32 v76, v76
  v_exp_f32 v77, v77
  s_setprio 3
  v_cvt_pk_bf16_f32 v41, v74, v75
  v_exp_f32 v78, v78
  v_exp_f32 v79, v79
  v_cvt_pk_bf16_f32 v42, v76, v77
  v_cvt_pk_bf16_f32 v43, v78, v79
  s_waitcnt lgkmcnt(0)
  v_mfma_f32_32x32x16_bf16 v[64:79], v[16:19], v[8:11], v[80:95]
  s_setprio 0
  ds_read_b128 v[12:15], v4 offset:4096
  v_exp_f32 v48, v48
  v_exp_f32 v49, v49
  v_mfma_f32_32x32x16_bf16 v[96:111], v[32:35], v[40:43], v[96:111]
  s_mov_b64 exec, s[36:37]
  ds_read_b128 v[28:31], v5 offset:3072
  ds_read_b128 v[32:35], v5 offset:3584
  s_mov_b64 exec, -1
  v_exp_f32 v50, v50
  v_exp_f32 v51, v51
  s_setprio 1
  v_cvt_pk_bf16_f32 v36, v48, v49
  v_exp_f32 v52, v52
  v_exp_f32 v53, v53
  v_cvt_pk_bf16_f32 v37, v50, v51
  v_exp_f32 v54, v54
  v_exp_f32 v55, v55
  s_setprio 2
  v_cvt_pk_bf16_f32 v38, v52, v53
  v_exp_f32 v56, v56
  v_exp_f32 v57, v57
  v_cvt_pk_bf16_f32 v39, v54, v55
  v_exp_f32 v58, v58
  v_exp_f32 v59, v59
  v_mfma_f32_32x32x16_bf16 v[96:111], v[20:23], v[36:39], v[96:111]
  v_cvt_pk_bf16_f32 v40, v56, v57
  v_exp_f32 v60, v60
  v_exp_f32 v61, v61
  s_setprio 3
  v_cvt_pk_bf16_f32 v41, v58, v59
  v_exp_f32 v62, v62
  v_exp_f32 v63, v63
  v_cvt_pk_bf16_f32 v42, v60, v61
  v_cvt_pk_bf16_f32 v43, v62, v63
  s_waitcnt lgkmcnt(0)
  v_mfma_f32_32x32x16_bf16 v[48:63], v[12:15], v[8:11], v[80:95]
  s_setprio 0
  ds_read_b128 v[16:19], v4 offset:5120
  v_exp_f32 v64, v64
  v_exp_f32 v65, v65
  v_mfma_f32_32x32x16_bf16 v[96:111], v[24:27], v[40:43], v[96:111]
  s_mov_b64 exec, s[36:37]
  ds_read_b128 v[20:23], v5 offset:4096
  ds_read_b128 v[24:27], v5 offset:4608
  s_mov_b64 exec, -1
  v_exp_f32 v66, v66
  v_exp_f32 v67, v67
  s_setprio 1
  v_cvt_pk_bf16_f32 v36, v64, v65
  v_exp_f32 v68, v68
  v_exp_f32 v69, v69
  v_cvt_pk_bf16_f32 v37, v66, v67
  v_exp_f32 v70, v70
  v_exp_f32 v71, v71
  s_setprio 2
  v_cvt_pk_bf16_f32 v38, v68, v69
  v_exp_f32 v72, v72
  v_exp_f32 v73, v73
  v_cvt_pk_bf16_f32 v39, v70, v71
  v_exp_f32 v74, v74
  v_exp_f32 v75, v75
  v_mfma_f32_32x32x16_bf16 v[96:111], v[28:31], v[36:39], v[96:111]
  v_cvt_pk_bf16_f32 v40, v72, v73
  v_exp_f32 v76, v76
  v_exp_f32 v77, v77
  s_setprio 3
  v_cvt_pk_bf16_f32 v41, v74, v75
  v_exp_f32 v78, v78
  v_exp_f32 v79, v79
  v_cvt_pk_bf16_f32 v42, v76, v77
  v_cvt_pk_bf16_f32 v43, v78, v79
  s_waitcnt lgkmcnt(0)
  v_mfma_f32_32x32x16_bf16 v[64:79], v[16:19], v[8:11], v[80:95]
  s_setprio 0
  ds_read_b128 v[12:15], v4 offset:6144
  v_exp_f32 v48, v48
  v_exp_f32 v49, v49
  v_mfma_f32_32x32x16_bf16 v[96:111], v[32:35], v[40:43], v[96:111]
  s_mov_b64 exec, s[36:37]
  ds_read_b128 v[28:31], v5 offset:5120
  ds_read_b128 v[32:35], v5 offset:5632
  s_mov_b64 exec, -1
  v_exp_f32 v50, v50
  v_exp_f32 v51, v51
  s_setprio 1
  v_cvt_pk_bf16_f32 v36, v48, v49
  v_exp_f32 v52, v52
  v_exp_f32 v53, v53
  v_cvt_pk_bf16_f32 v37, v50, v51
  v_exp_f32 v54, v54
  v_exp_f32 v55, v55
  s_setprio 2
  v_cvt_pk_bf16_f32 v38, v52, v53
  v_exp_f32 v56, v56
  v_exp_f32 v57, v57
  v_cvt_pk_bf16_f32 v39, v54, v55
  v_exp_f32 v58, v58
  v_exp_f32 v59, v59
  v_mfma_f32_32x32x16_bf16 v[96:111], v[20:23], v[36:39], v[96:111]
  v_cvt_pk_bf16_f32 v40, v56, v57
  v_exp_f32 v60, v60
  v_exp_f32 v61, v61
  s_setprio 3
  v_cvt_pk_bf16_f32 v41, v58, v59
  v_exp_f32 v62, v62
  v_exp_f32 v63, v63
  v_cvt_pk_bf16_f32 v42, v60, v61
  v_cvt_pk_bf16_f32 v43, v62, v63
  s_waitcnt lgkmcnt(0)
  v_mfma_f32_32x32x16_bf16 v[48:63], v[12:15], v[8:11], v[80:95]
  s_setprio 0
  ds_read_b128 v[16:19], v4 offset:7168
  v_exp_f32 v64, v64
  v_exp_f32 v65, v65
  v_mfma_f32_32x32x16_bf16 v[96:111], v[24:27], v[40:43], v[96:111]
  s_mov_b64 exec, s[36:37]
  ds_read_b128 v[20:23], v5 offset:6144
  ds_read_b128 v[24:27], v5 offset:6656
  s_mov_b64 exec, -1
  ds_read_b32 v112, v6
  v_exp_f32 v66, v66
  v_exp_f32 v67, v67
  s_setprio 1
  v_cvt_pk_bf16_f32 v36, v64, v65
  v_exp_f32 v68, v68
  v_exp_f32 v69, v69
  v_cvt_pk_bf16_f32 v37, v66, v67
  v_exp_f32 v70, v70
  v_exp_f32 v71, v71
  s_setprio 2
  v_cvt_pk_bf16_f32 v38, v68, v69
  v_exp_f32 v72, v72
  v_exp_f32 v73, v73
  v_cvt_pk_bf16_f32 v39, v70, v71
  v_exp_f32 v74, v74
  v_exp_f32 v75, v75
  v_mfma_f32_32x32x16_bf16 v[96:111], v[28:31], v[36:39], v[96:111]
  v_cvt_pk_bf16_f32 v40, v72, v73
  v_exp_f32 v76, v76
  v_exp_f32 v77, v77
  s_setprio 3
  v_cvt_pk_bf16_f32 v41, v74, v75
  v_exp_f32 v78, v78
  v_exp_f32 v79, v79
  v_cvt_pk_bf16_f32 v42, v76, v77
  v_cvt_pk_bf16_f32 v43, v78, v79
  s_waitcnt lgkmcnt(0)
sequential_preLN__softmax_full_mha__glu_gated_reglu__prompt_kernel_chk67:
  v_cmp_ge_u32 vcc, s38, v112
  s_cmp_lg_u64 vcc, 0
  s_cbranch_scc1 sequential_preLN__softmax_full_mha__glu_gated_reglu__prompt_kernel_spin68
  v_mfma_f32_32x32x16_bf16 v[64:79], v[16:19], v[8:11], v[80:95]
  s_setprio 0
  ds_read_b128 v[12:15], v4 offset:8192
  v_exp_f32 v48, v48
  v_exp_f32 v49, v49
  v_mfma_f32_32x32x16_bf16 v[96:111], v[32:35], v[40:43], v[96:111]
  s_mov_b64 exec, s[36:37]
  ds_read_b128 v[28:31], v5 offset:7168
  ds_read_b128 v[32:35], v5 offset:7680
  s_mov_b64 exec, -1
  v_exp_f32 v50, v50
  v_exp_f32 v51, v51
  s_setprio 1
  v_cvt_pk_bf16_f32 v36, v48, v49
  v_exp_f32 v52, v52
  v_exp_f32 v53, v53
  v_cvt_pk_bf16_f32 v37, v50, v51
  v_exp_f32 v54, v54
  v_exp_f32 v55, v55
  s_setprio 2
  v_cvt_pk_bf16_f32 v38, v52, v53
  v_exp_f32 v56, v56
  v_exp_f32 v57, v57
  v_cvt_pk_bf16_f32 v39, v54, v55
  v_exp_f32 v58, v58
  v_exp_f32 v59, v59
  v_mfma_f32_32x32x16_bf16 v[96:111], v[20:23], v[36:39], v[96:111]
  v_cvt_pk_bf16_f32 v40, v56, v57
  v_exp_f32 v60, v60
  v_exp_f32 v61, v61
  s_setprio 3
  v_cvt_pk_bf16_f32 v41, v58, v59
  v_exp_f32 v62, v62
  v_exp_f32 v63, v63
  v_cvt_pk_bf16_f32 v42, v60, v61
  v_cvt_pk_bf16_f32 v43, v62, v63
  s_waitcnt lgkmcnt(0)
  v_mfma_f32_32x32x16_bf16 v[48:63], v[12:15], v[8:11], v[80:95]
  s_setprio 0
  ds_read_b128 v[16:19], v4 offset:9216
  v_exp_f32 v64, v64
  v_exp_f32 v65, v65
  v_mfma_f32_32x32x16_bf16 v[96:111], v[24:27], v[40:43], v[96:111]
  s_mov_b64 exec, s[36:37]
  ds_read_b128 v[20:23], v5 offset:8192
  ds_read_b128 v[24:27], v5 offset:8704
  s_mov_b64 exec, -1
  v_exp_f32 v66, v66
  v_exp_f32 v67, v67
  s_setprio 1
  v_cvt_pk_bf16_f32 v36, v64, v65
  v_exp_f32 v68, v68
  v_exp_f32 v69, v69
  v_cvt_pk_bf16_f32 v37, v66, v67
  v_exp_f32 v70, v70
  v_exp_f32 v71, v71
  s_setprio 2
  v_cvt_pk_bf16_f32 v38, v68, v69
  v_exp_f32 v72, v72
  v_exp_f32 v73, v73
  v_cvt_pk_bf16_f32 v39, v70, v71
  v_exp_f32 v74, v74
  v_exp_f32 v75, v75
  v_mfma_f32_32x32x16_bf16 v[96:111], v[28:31], v[36:39], v[96:111]
  v_cvt_pk_bf16_f32 v40, v72, v73
  v_exp_f32 v76, v76
  v_exp_f32 v77, v77
  s_setprio 3
  v_cvt_pk_bf16_f32 v41, v74, v75
  v_exp_f32 v78, v78
  v_exp_f32 v79, v79
  v_cvt_pk_bf16_f32 v42, v76, v77
  v_add_u32 v4, 8192, v4
  v_add_u32 v5, 8192, v5
  s_add_u32 s38, s38, 1
  v_mov_b32 v112, s38
  ds_write_b32 v6, v112 offset:32
  s_cmp_lt_u32 s38, 8
  v_cvt_pk_bf16_f32 v43, v78, v79
  s_cbranch_scc1 sequential_preLN__softmax_full_mha__glu_gated_reglu__prompt_kernel_loop69
  s_setprio 0
  s_nop 0
  v_mfma_f32_32x32x16_bf16 v[96:111], v[32:35], v[40:43], v[96:111]
  s_waitcnt lgkmcnt(0)
  s_nop 10
  v_rcp_f32 v44, v104
  s_nop 0
  v_mul_f32 v64, v96, v44
  v_mul_f32 v65, v97, v44
  v_mul_f32 v66, v98, v44
  v_mul_f32 v67, v99, v44
  v_mul_f32 v68, v100, v44
  v_mul_f32 v69, v101, v44
  v_mul_f32 v70, v102, v44
  v_mul_f32 v71, v103, v44
  v_cvt_pk_bf16_f32 v36, v64, v65
  v_cvt_pk_bf16_f32 v37, v66, v67
  v_cvt_pk_bf16_f32 v38, v68, v69
  v_cvt_pk_bf16_f32 v39, v70, v71
  buffer_store_dwordx4 v[36:39], v3, s[20:23], s42 offen sc1
  v_max3_f32 v44, abs(v96), abs(v97), abs(v98)
  v_max3_f32 v45, abs(v99), abs(v100), abs(v101)
  v_max3_f32 v44, v44, abs(v102), abs(v103)
  v_add_f32 v46, v96, v97
  v_max3_f32 v44, v44, v45, v104
  s_mov_b32 s39, 0x71800000
  v_add_f32 v46, v46, v98
  v_add_f32 v46, v46, v99
  v_add_f32 v46, v46, v100
  v_add_f32 v46, v46, v101
  v_add_f32 v46, v46, v102
  v_add_f32 v46, v46, v103
  v_add_f32 v46, v46, v104
  v_and_b32 v46, 0x7fffffff, v46
  v_cmp_ngt_f32 vcc, s39, v44
  v_cmp_ngt_f32 s[40:41], s39, v46
  s_nop 0
  s_or_b64 s[40:41], s[40:41], vcc
  s_cmp_lg_u64 s[40:41], 0
  s_cbranch_scc1 sequential_preLN__softmax_full_mha__glu_gated_reglu__prompt_kernel_fb70
sequential_preLN__softmax_full_mha__glu_gated_reglu__prompt_kernel_fin71:
  s_waitcnt vmcnt(0)
  s_barrier
  s_barrier
  s_cmp_ge_u32 s26, 4
  s_cbranch_scc1 sequential_preLN__softmax_full_mha__glu_gated_reglu__prompt_kernel_L372
  s_lshl_b32 s27, s24, 2
  s_and_b32 s28, s25, 3
  s_add_u32 s27, s27, s28
  s_lshr_b32 s28, s25, 2
  s_and_b32 s29, s26, 1
  s_lshl_b32 s30, s27, 1
  s_add_u32 s30, s30, s29
  s_lshr_b32 s31, s26, 1
  s_lshl_b32 s32, s28, 1
  s_add_u32 s32, s32, s31
  s_mul_i32 s33, s31, 3072
  v_add_u32 v6, s33, v3
  s_lshl_b32 s33, s31, 10
  s_add_u32 s33, s33, 1024
  v_add_u32 v7, s33, v3
  s_mul_i32 s34, s31, 16
  s_mul_i32 s35, s30, 32
  s_add_u32 s35, s35, s34
  s_lshl_b32 s35, s35, 10
  s_add_u32 s35, s35, 6291456
  s_lshl_b32 s40, s30, 5
  s_lshl_b32 s41, s32, 1
  s_add_u32 s40, s40, s41
  s_lshl_b32 s40, s40, 10
  s_add_u32 s41, s40, 8388608
  buffer_load_dwordx4 v[8:11], v3, s[20:23], s41 offen sc1
  buffer_load_dwordx4 v[12:15], v3, s[20:23], s41 offen offset:1024 sc1
  s_add_u32 s41, s40, 10485760
  s_lshl_b32 s47, s32, 13
  s_lshl_b32 s48, s30, 7
  s_add_u32 s47, s47, s48
  s_add_u32 s47, s47, 25165824
  s_add_u32 s48, s48, 25690112
  v_bfe_u32 v0, v2, 1, 1
  v_lshlrev_b32 v0, 5, v0
  v_lshrrev_b32 v1, 5, v2
  v_lshl_add_u32 v0, v1, 4, v0
  s_mov_b32 s42, 0x000a0005
  s_mov_b32 s43, 0x000a0005
  s_lshl_b32 s33, s31, 10
  s_add_u32 s33, s33, 160768
  v_add_u32 v0, s33, v0
  s_xor_b32 s36, s26, 2
  s_lshl_b32 s37, s36, 12
  s_add_u32 s37, s37, 102400
  v_add_u32 v4, s37, v3
  s_lshl_b32 s36, s36, 8
  s_add_u32 s39, s36, 118784
  s_xor_b32 s36, s26, 0
  s_lshl_b32 s37, s36, 12
  s_add_u32 s37, s37, 102400
  v_add_u32 v5, s37, v3
  s_lshl_b32 s36, s36, 8
  s_add_u32 s38, s36, 118784
  s_mov_b32 s45, 0xffff0000
  v_mov_b32 v160, 0
  v_mov_b32 v161, 0
  v_mov_b32 v162, 0
  v_mov_b32 v163, 0
  v_mov_b32 v164, 0
  v_mov_b32 v165, 0
  v_mov_b32 v166, 0
  v_mov_b32 v167, 0
  s_waitcnt vmcnt(0)
  v_lshlrev_b32 v16, 16, v8
  v_and_b32 v17, s45, v8
  v_lshlrev_b32 v18, 16, v9
  v_and_b32 v19, s45, v9
  v_lshlrev_b32 v20, 16, v10
  v_and_b32 v21, s45, v10
  v_lshlrev_b32 v22, 16, v11
  v_and_b32 v23, s45, v11
  v_lshlrev_b32 v24, 16, v12
  v_and_b32 v25, s45, v12
  v_lshlrev_b32 v26, 16, v13
  v_and_b32 v27, s45, v13
  v_lshlrev_b32 v28, 16, v14
  v_and_b32 v29, s45, v14
  v_lshlrev_b32 v30, 16, v15
  v_and_b32 v31, s45, v15
  s_setprio 3
  s_barrier
  v_and_b32 v1, 31, v2
  v_lshlrev_b32 v1, 2, v1
  buffer_load_dword v1, v1, s[20:23], s48 offen sc1
  s_add_u32 s36, s35, 0
  buffer_load_dwordx4 v[80:83], v3, s[20:23], s36 offen sc1
  buffer_load_dwordx4 v[84:87], v3, s[20:23], s36 offen offset:1024 sc1
  buffer_load_dwordx4 v[88:91], v3, s[20:23], s36 offen offset:2048 sc1
  buffer_load_dwordx4 v[92:95], v3, s[20:23], s36 offen offset:3072 sc1
  s_add_u32 s36, s35, 4096
  buffer_load_dwordx4 v[96:99], v3, s[20:23], s36 offen sc1
  buffer_load_dwordx4 v[100:103], v3, s[20:23], s36 offen offset:1024 sc1
  buffer_load_dwordx4 v[104:107], v3, s[20:23], s36 offen offset:2048 sc1
  buffer_load_dwordx4 v[108:111], v3, s[20:23], s36 offen offset:3072 sc1
  s_add_u32 s36, s35, 8192
  buffer_load_dwordx4 v[112:115], v3, s[20:23], s36 offen sc1
  buffer_load_dwordx4 v[116:119], v3, s[20:23], s36 offen offset:1024 sc1
  buffer_load_dwordx4 v[120:123], v3, s[20:23], s36 offen offset:2048 sc1
  buffer_load_dwordx4 v[124:127], v3, s[20:23], s36 offen offset:3072 sc1
  s_add_u32 s36, s35, 12288
  buffer_load_dwordx4 v[128:131], v3, s[20:23], s36 offen sc1
  buffer_load_dwordx4 v[132:135], v3, s[20:23], s36 offen offset:1024 sc1
  buffer_load_dwordx4 v[136:139], v3, s[20:23], s36 offen offset:2048 sc1
  buffer_load_dwordx4 v[140:143], v3, s[20:23], s36 offen offset:3072 sc1
  s_setprio 0
  v_add_u32 v6, 132096, v6
  v_add_u32 v7, 132096, v7
  ds_read_b128 v[48:51], v6 offset:0
  ds_read_b128 v[52:55], v7 offset:0
  s_mov_b64 exec, s[42:43]
  ds_read_b128 v[160:163], v0 offset:0
  s_mov_b64 exec, -1
  ds_read_b128 v[56:59], v6 offset:4096
  ds_read_b128 v[60:63], v7 offset:4096
  s_mov_b64 exec, s[42:43]
  ds_read_b128 v[164:167], v0 offset:64
  s_mov_b64 exec, -1
  ds_read_b128 v[64:67], v6 offset:8192
  ds_read_b128 v[68:71], v7 offset:8192
  s_waitcnt vmcnt(15) lgkmcnt(5)
  v_mfma_f32_32x32x16_bf16 v[16:31], v[48:51], v[80:83], v[16:31]
  ds_read_b128 v[72:75], v6 offset:12288
  v_mfma_f32_32x32x16_bf16 v[32:47], v[52:55], v[80:83], 0
  ds_read_b128 v[76:79], v7 offset:12288
  v_mfma_f32_16x16x32_bf16 v[144:147], v[160:163], v[80:83], 0
  s_mov_b64 exec, s[42:43]
  ds_read_b128 v[160:163], v0 offset:128
  s_mov_b64 exec, -1
  s_waitcnt vmcnt(14) lgkmcnt(5)
  v_mfma_f32_32x32x16_bf16 v[16:31], v[56:59], v[84:87], v[16:31]
  ds_read_b128 v[48:51], v6 offset:16384
  v_mfma_f32_32x32x16_bf16 v[32:47], v[60:63], v[84:87], v[32:47]
  ds_read_b128 v[52:55], v7 offset:16384
  v_mfma_f32_16x16x32_bf16 v[144:147], v[164:167], v[84:87], v[144:147]
  s_mov_b64 exec, s[42:43]
  ds_read_b128 v[164:167], v0 offset:192
  s_mov_b64 exec, -1
  s_waitcnt vmcnt(13) lgkmcnt(3)
  v_mfma_f32_32x32x16_bf16 v[16:31], v[64:67], v[88:91], v[16:31]
  ds_read_b128 v[56:59], v6 offset:20480
  v_mfma_f32_32x32x16_bf16 v[32:47], v[68:71], v[88:91], v[32:47]
  ds_read_b128 v[60:63], v7 offset:20480
  v_mfma_f32_16x16x32_bf16 v[144:147], v[160:163], v[88:91], v[144:147]
  s_mov_b64 exec, s[42:43]
  ds_read_b128 v[160:163], v0 offset:256
  s_mov_b64 exec, -1
  s_waitcnt vmcnt(12) lgkmcnt(3)
  v_mfma_f32_32x32x16_bf16 v[16:31], v[72:75], v[92:95], v[16:31]
  ds_read_b128 v[64:67], v6 offset:24576
  v_mfma_f32_32x32x16_bf16 v[32:47], v[76:79], v[92:95], v[32:47]
  ds_read_b128 v[68:71], v7 offset:24576
  v_mfma_f32_16x16x32_bf16 v[144:147], v[164:167], v[92:95], v[144:147]
  s_mov_b64 exec, s[42:43]
  ds_read_b128 v[164:167], v0 offset:320
  s_mov_b64 exec, -1
  s_waitcnt vmcnt(11) lgkmcnt(3)
  v_mfma_f32_32x32x16_bf16 v[16:31], v[48:51], v[96:99], v[16:31]
  v_add_u32 v6, -119808, v6
  v_add_u32 v7, -119808, v7
  ds_read_b128 v[72:75], v6 offset:0
  v_mfma_f32_32x32x16_bf16 v[32:47], v[52:55], v[96:99], v[32:47]
  ds_read_b128 v[76:79], v7 offset:0
  v_mfma_f32_16x16x32_bf16 v[144:147], v[160:163], v[96:99], v[144:147]
  s_mov_b64 exec, s[42:43]
  ds_read_b128 v[160:163], v0 offset:384
  s_mov_b64 exec, -1
  s_waitcnt vmcnt(10) lgkmcnt(3)
  v_mfma_f32_32x32x16_bf16 v[16:31], v[56:59], v[100:103], v[16:31]
  ds_read_b128 v[48:51], v6 offset:4096
  v_mfma_f32_32x32x16_bf16 v[32:47], v[60:63], v[100:103], v[32:47]
  ds_read_b128 v[52:55], v7 offset:4096
  v_mfma_f32_16x16x32_bf16 v[144:147], v[164:167], v[100:103], v[144:147]
  s_mov_b64 exec, s[42:43]
  ds_read_b128 v[164:167], v0 offset:448
  s_mov_b64 exec, -1
  s_waitcnt vmcnt(9) lgkmcnt(3)
  v_mfma_f32_32x32x16_bf16 v[16:31], v[64:67], v[104:107], v[16:31]
  ds_read_b128 v[56:59], v6 offset:20480
  v_mfma_f32_32x32x16_bf16 v[32:47], v[68:71], v[104:107], v[32:47]
  ds_read_b128 v[60:63], v7 offset:20480
  v_mfma_f32_16x16x32_bf16 v[144:147], v[160:163], v[104:107], v[144:147]
  s_mov_b64 exec, s[42:43]
  ds_read_b128 v[160:163], v0 offset:512
  s_mov_b64 exec, -1
  s_waitcnt vmcnt(8) lgkmcnt(3)
  v_mfma_f32_32x32x16_bf16 v[16:31], v[72:75], v[108:111], v[16:31]
  ds_read_b128 v[64:67], v6 offset:24576
  v_mfma_f32_32x32x16_bf16 v[32:47], v[76:79], v[108:111], v[32:47]
  ds_read_b128 v[68:71], v7 offset:24576
  v_mfma_f32_16x16x32_bf16 v[144:147], v[164:167], v[108:111], v[144:147]
  s_mov_b64 exec, s[42:43]
  ds_read_b128 v[164:167], v0 offset:576
  s_mov_b64 exec, -1
  s_waitcnt vmcnt(7) lgkmcnt(3)
  v_mfma_f32_32x32x16_bf16 v[16:31], v[48:51], v[112:115], v[16:31]
  ds_read_b128 v[72:75], v6 offset:40960
  v_mfma_f32_32x32x16_bf16 v[32:47], v[52:55], v[112:115], v[32:47]
  ds_read_b128 v[76:79], v7 offset:40960
  v_mfma_f32_16x16x32_bf16 v[144:147], v[160:163], v[112:115], v[144:147]
  s_mov_b64 exec, s[42:43]
  ds_read_b128 v[160:163], v0 offset:640
  s_mov_b64 exec, -1
  s_waitcnt vmcnt(6) lgkmcnt(3)
  v_mfma_f32_32x32x16_bf16 v[16:31], v[56:59], v[116:119], v[16:31]
  ds_read_b128 v[48:51], v6 offset:45056
  v_mfma_f32_32x32x16_bf16 v[32:47], v[60:63], v[116:119], v[32:47]
  ds_read_b128 v[52:55], v7 offset:45056
  v_mfma_f32_16x16x32_bf16 v[144:147], v[164:167], v[116:119], v[144:147]
  s_mov_b64 exec, s[42:43]
  ds_read_b128 v[164:167], v0 offset:704
  s_mov_b64 exec, -1
  s_waitcnt vmcnt(5) lgkmcnt(3)
  v_mfma_f32_32x32x16_bf16 v[16:31], v[64:67], v[120:123], v[16:31]
  ds_read_b128 v[56:59], v6 offset:61440
  v_mfma_f32_32x32x16_bf16 v[32:47], v[68:71], v[120:123], v[32:47]
  ds_read_b128 v[60:63], v7 offset:61440
  v_mfma_f32_16x16x32_bf16 v[144:147], v[160:163], v[120:123], v[144:147]
  s_mov_b64 exec, s[42:43]
  ds_read_b128 v[160:163], v0 offset:768
  s_mov_b64 exec, -1
  s_waitcnt vmcnt(4) lgkmcnt(3)
  v_mfma_f32_32x32x16_bf16 v[16:31], v[72:75], v[124:127], v[16:31]
  v_add_u32 v6, 65536, v6
  v_add_u32 v7, 65536, v7
  ds_read_b128 v[64:67], v6 offset:0
  v_mfma_f32_32x32x16_bf16 v[32:47], v[76:79], v[124:127], v[32:47]
  ds_read_b128 v[68:71], v7 offset:0
  v_mfma_f32_16x16x32_bf16 v[144:147], v[164:167], v[124:127], v[144:147]
  s_mov_b64 exec, s[42:43]
  ds_read_b128 v[164:167], v0 offset:832
  s_mov_b64 exec, -1
  s_waitcnt vmcnt(3) lgkmcnt(3)
  v_mfma_f32_32x32x16_bf16 v[16:31], v[48:51], v[128:131], v[16:31]
  ds_read_b128 v[72:75], v6 offset:16384
  v_mfma_f32_32x32x16_bf16 v[32:47], v[52:55], v[128:131], v[32:47]
  ds_read_b128 v[76:79], v7 offset:16384
  v_mfma_f32_16x16x32_bf16 v[144:147], v[160:163], v[128:131], v[144:147]
  s_mov_b64 exec, s[42:43]
  ds_read_b128 v[160:163], v0 offset:896
  s_mov_b64 exec, -1
  s_waitcnt vmcnt(2) lgkmcnt(3)
  v_mfma_f32_32x32x16_bf16 v[16:31], v[56:59], v[132:135], v[16:31]
  v_mfma_f32_32x32x16_bf16 v[32:47], v[60:63], v[132:135], v[32:47]
  v_mfma_f32_16x16x32_bf16 v[144:147], v[164:167], v[132:135], v[144:147]
  s_mov_b64 exec, s[42:43]
  ds_read_b128 v[164:167], v0 offset:960
  s_mov_b64 exec, -1
  s_waitcnt vmcnt(1) lgkmcnt(1)
  v_mfma_f32_32x32x16_bf16 v[16:31], v[64:67], v[136:139], v[16:31]
  v_mfma_f32_32x32x16_bf16 v[32:47], v[68:71], v[136:139], v[32:47]
  v_mfma_f32_16x16x32_bf16 v[144:147], v[160:163], v[136:139], v[144:147]
  s_waitcnt vmcnt(0) lgkmcnt(0)
  v_mfma_f32_16x16x32_bf16 v[144:147], v[164:167], v[140:143], v[144:147]
  v_mfma_f32_32x32x16_bf16 v[32:47], v[76:79], v[140:143], v[32:47]
  v_mfma_f32_32x32x16_bf16 v[16:31], v[72:75], v[140:143], v[16:31]
  v_lshl_add_u32 v8, v2, 2, s38
  v_and_b32 v9, 31, v2
  v_lshl_add_u32 v10, v9, 2, s39
  v_lshl_add_u32 v9, v9, 2, s38
  s_nop 1
  v_add_f32 v144, v144, v146
  v_add_f32 v145, v145, v147
  s_mov_b64 exec, 0xffff
  ds_write2_b32 v8, v144, v145 offset0:0 offset1:16
  s_mov_b64 exec, -1
  ds_write_b128 v4, v[32:35] offset:0
  ds_write_b128 v4, v[36:39] offset:1024
  ds_write_b128 v4, v[40:43] offset:2048
  ds_write_b128 v4, v[44:47] offset:3072
  s_waitcnt lgkmcnt(0)
  s_barrier
  ds_read_b32 v146, v9
  ds_read_b32 v147, v10
  ds_read_b128 v[48:51], v5 offset:0
  ds_read_b128 v[52:55], v5 offset:1024
  ds_read_b128 v[56:59], v5 offset:2048
  ds_read_b128 v[60:63], v5 offset:3072
  s_waitcnt lgkmcnt(3)
  v_add_f32 v0, v1, v146
  v_add_f32 v0, v0, v147
  v_pk_add_f32 v[16:17], v[16:17], v[48:49]
  v_pk_add_f32 v[18:19], v[18:19], v[50:51]
  v_pk_add_f32 v[48:49], v[16:17], v[0:1] op_sel_hi:[1,0] neg_lo:[0,1] neg_hi:[0,1]
  v_pk_add_f32 v[50:51], v[18:19], v[0:1] op_sel_hi:[1,0] neg_lo:[0,1] neg_hi:[0,1]
  v_cvt_pk_bf16_f32 v64, v48, v49
  v_cvt_pk_bf16_f32 v65, v50, v51
  v_lshlrev_b32 v76, 2, v2
  v_dot2_f32_bf16 v72, v64, v64, 0
  v_dot2_f32_bf16 v73, v65, v65, 0
  s_waitcnt lgkmcnt(2)
  v_pk_add_f32 v[20:21], v[20:21], v[52:53]
  v_pk_add_f32 v[22:23], v[22:23], v[54:55]
  v_pk_add_f32 v[52:53], v[20:21], v[0:1] op_sel_hi:[1,0] neg_lo:[0,1] neg_hi:[0,1]
  v_pk_add_f32 v[54:55], v[22:23], v[0:1] op_sel_hi:[1,0] neg_lo:[0,1] neg_hi:[0,1]
  v_cvt_pk_bf16_f32 v66, v52, v53
  v_cvt_pk_bf16_f32 v67, v54, v55
  buffer_store_dwordx4 v[64:67], v3, s[20:23], s41 offen sc1
  v_dot2_f32_bf16 v72, v66, v66, v72
  v_dot2_f32_bf16 v73, v67, v67, v73
  s_waitcnt lgkmcnt(1)
  v_pk_add_f32 v[24:25], v[24:25], v[56:57]
  v_pk_add_f32 v[26:27], v[26:27], v[58:59]
  v_pk_add_f32 v[56:57], v[24:25], v[0:1] op_sel_hi:[1,0] neg_lo:[0,1] neg_hi:[0,1]
  v_pk_add_f32 v[58:59], v[26:27], v[0:1] op_sel_hi:[1,0] neg_lo:[0,1] neg_hi:[0,1]
  v_cvt_pk_bf16_f32 v68, v56, v57
  v_cvt_pk_bf16_f32 v69, v58, v59
  v_dot2_f32_bf16 v72, v68, v68, v72
  v_dot2_f32_bf16 v73, v69, v69, v73
  s_waitcnt lgkmcnt(0)
  v_pk_add_f32 v[28:29], v[28:29], v[60:61]
  v_pk_add_f32 v[30:31], v[30:31], v[62:63]
  v_pk_add_f32 v[60:61], v[28:29], v[0:1] op_sel_hi:[1,0] neg_lo:[0,1] neg_hi:[0,1]
  v_pk_add_f32 v[62:63], v[30:31], v[0:1] op_sel_hi:[1,0] neg_lo:[0,1] neg_hi:[0,1]
  v_cvt_pk_bf16_f32 v70, v60, v61
  v_cvt_pk_bf16_f32 v71, v62, v63
  buffer_store_dwordx4 v[68:71], v3, s[20:23], s41 offen offset:1024 sc1
  v_dot2_f32_bf16 v72, v70, v70, v72
  v_dot2_f32_bf16 v73, v71, v71, v73
  s_nop 2
  v_add_f32 v72, v72, v73
  v_mov_b32 v74, v72
  v_mov_b32 v75, v72
  s_nop 1
  v_permlane32_swap_b32 v74, v75
  s_nop 0
  v_add_f32 v72, v74, v75
  s_mov_b32 exec_hi, 0
  buffer_store_dword v72, v76, s[20:23], s47 offen sc1
  s_mov_b64 exec, -1
  v_cvt_pk_bf16_f32 v160, v16, v17
  v_cvt_pk_bf16_f32 v161, v18, v19
  v_cvt_pk_bf16_f32 v162, v20, v21
  v_cvt_pk_bf16_f32 v163, v22, v23
  v_cvt_pk_bf16_f32 v164, v24, v25
  v_cvt_pk_bf16_f32 v165, v26, v27
  v_cvt_pk_bf16_f32 v166, v28, v29
  v_cvt_pk_bf16_f32 v167, v30, v31
  v_lshlrev_b32 v0, 7, v2
  s_waitcnt vmcnt(0)
  s_barrier
  s_setprio 1
  s_lshl_b32 s27, s24, 1
  s_cmp_ge_u32 s25, 15
  s_cselect_b32 s28, 1, 0
  s_add_u32 s27, s27, s28
  s_mul_i32 s28, s28, 15
  s_sub_u32 s28, s25, s28
  s_min_u32 s28, s28, 15
  s_cmp_eq_u32 s28, 15
  s_cbranch_scc1 sequential_preLN__softmax_full_mha__glu_gated_reglu__prompt_kernel_p4skip73
  s_and_b32 s29, s26, 1
  s_lshr_b32 s31, s26, 1
  s_lshl_b32 s30, s27, 2
  s_lshl_b32 s33, s29, 1
  s_add_u32 s30, s30, s33
  s_lshl_b32 s33, s29, 12
  s_add_u32 s33, s33, 12288
  v_add_u32 v7, s33, v3
  s_mul_i32 s33, s31, 6144
  v_add_u32 v6, s33, v3
  s_mul_i32 s40, s30, 86
  s_mul_i32 s41, s28, 6
  s_mul_i32 s33, s31, 3
  s_add_u32 s41, s41, s33
  s_add_u32 s40, s40, s41
  s_lshl_b32 s40, s40, 10
  s_add_u32 s40, s40, 12582912
  s_mov_b32 s47, 0
  s_lshl_b32 s32, s30, 7
  s_add_u32 s32, s32, 25165824
  v_and_b32 v4, 31, v2
  v_lshlrev_b32 v4, 2, v4
  v_lshrrev_b32 v8, 5, v2
  v_lshl_add_u32 v4, v8, 13, v4
  s_mov_b32 s48, 0
  v_mov_b32 v64, 0
  v_mov_b32 v65, 0
  v_mov_b32 v66, 0
  v_mov_b32 v67, 0
  v_mov_b32 v68, 0
  v_mov_b32 v69, 0
  v_mov_b32 v70, 0
  v_mov_b32 v71, 0
  v_mov_b32 v72, 0
  v_mov_b32 v73, 0
  v_mov_b32 v74, 0
  v_mov_b32 v75, 0
  v_mov_b32 v76, 0
  v_mov_b32 v77, 0
  v_mov_b32 v78, 0
  v_mov_b32 v79, 0
  v_mov_b32 v80, 0
  v_mov_b32 v81, 0
  v_mov_b32 v82, 0
  v_mov_b32 v83, 0
  v_mov_b32 v84, 0
  v_mov_b32 v85, 0
  v_mov_b32 v86, 0
  v_mov_b32 v87, 0
  v_mov_b32 v88, 0
  v_mov_b32 v89, 0
  v_mov_b32 v90, 0
  v_mov_b32 v91, 0
  v_mov_b32 v92, 0
  v_mov_b32 v93, 0
  v_mov_b32 v94, 0
  v_mov_b32 v95, 0
  v_mov_b32 v96, 0
  v_mov_b32 v97, 0
  v_mov_b32 v98, 0
  v_mov_b32 v99, 0
  v_mov_b32 v100, 0
  v_mov_b32 v101, 0
  v_mov_b32 v102, 0
  v_mov_b32 v103, 0
  v_mov_b32 v104, 0
  v_mov_b32 v105, 0
  v_mov_b32 v106, 0
  v_mov_b32 v107, 0
  v_mov_b32 v108, 0
  v_mov_b32 v109, 0
  v_mov_b32 v110, 0
  v_mov_b32 v111, 0
  v_mov_b32 v112, 0
  v_mov_b32 v113, 0
  v_mov_b32 v114, 0
  v_mov_b32 v115, 0
  v_mov_b32 v116, 0
  v_mov_b32 v117, 0
  v_mov_b32 v118, 0
  v_mov_b32 v119, 0
  v_mov_b32 v120, 0
  v_mov_b32 v121, 0
  v_mov_b32 v122, 0
  v_mov_b32 v123, 0
  v_mov_b32 v124, 0
  v_mov_b32 v125, 0
  v_mov_b32 v126, 0
  v_mov_b32 v127, 0
  v_mov_b32 v128, 0
  v_mov_b32 v129, 0
  v_mov_b32 v130, 0
  v_mov_b32 v131, 0
  v_mov_b32 v132, 0
  v_mov_b32 v133, 0
  v_mov_b32 v134, 0
  v_mov_b32 v135, 0
  v_mov_b32 v136, 0
  v_mov_b32 v137, 0
  v_mov_b32 v138, 0
  v_mov_b32 v139, 0
  v_mov_b32 v140, 0
  v_mov_b32 v141, 0
  v_mov_b32 v142, 0
  v_mov_b32 v143, 0
  v_mov_b32 v144, 0
  v_mov_b32 v145, 0
  v_mov_b32 v146, 0
  v_mov_b32 v147, 0
  v_mov_b32 v148, 0
  v_mov_b32 v149, 0
  v_mov_b32 v150, 0
  v_mov_b32 v151, 0
  v_mov_b32 v152, 0
  v_mov_b32 v153, 0
  v_mov_b32 v154, 0
  v_mov_b32 v155, 0
  v_mov_b32 v156, 0
  v_mov_b32 v157, 0
  v_mov_b32 v158, 0
  v_mov_b32 v159, 0
  s_barrier
  s_add_u32 s35, s32, 0
  buffer_load_dword v48, v4, s[20:23], s35 offen sc1
  buffer_load_dword v56, v4, s[20:23], s35 offen offset:128 sc1
  s_add_u32 s35, s32, 16384
  buffer_load_dword v49, v4, s[20:23], s35 offen sc1
  buffer_load_dword v57, v4, s[20:23], s35 offen offset:128 sc1
  s_add_u32 s35, s32, 32768
  buffer_load_dword v50, v4, s[20:23], s35 offen sc1
  buffer_load_dword v58, v4, s[20:23], s35 offen offset:128 sc1
  s_add_u32 s35, s32, 49152
  buffer_load_dword v51, v4, s[20:23], s35 offen sc1
  buffer_load_dword v59, v4, s[20:23], s35 offen offset:128 sc1
  s_add_u32 s35, s32, 65536
  buffer_load_dword v52, v4, s[20:23], s35 offen sc1
  buffer_load_dword v60, v4, s[20:23], s35 offen offset:128 sc1
  s_add_u32 s35, s32, 81920
  buffer_load_dword v53, v4, s[20:23], s35 offen sc1
  buffer_load_dword v61, v4, s[20:23], s35 offen offset:128 sc1
  s_add_u32 s35, s32, 98304
  buffer_load_dword v54, v4, s[20:23], s35 offen sc1
  buffer_load_dword v62, v4, s[20:23], s35 offen offset:128 sc1
  s_add_u32 s35, s32, 114688
  buffer_load_dword v55, v4, s[20:23], s35 offen sc1
  buffer_load_dword v63, v4, s[20:23], s35 offen offset:128 sc1
  s_barrier
  ds_read_b128 v[24:27], v6 offset:0
  ds_read_b128 v[8:11], v7 offset:0
  ds_read_b128 v[12:15], v7 offset:2048
  ds_read_b128 v[28:31], v6 offset:2048
  ds_read_b128 v[32:35], v6 offset:4096
  .p2align 3
sequential_preLN__softmax_full_mha__glu_gated_reglu__prompt_kernel_p4ml75:
  s_waitcnt lgkmcnt(2)
  v_mfma_f32_32x32x16_bf16 v[64:79], v[24:27], v[8:11], v[64:79]
  ds_read_b128 v[36:39], v6 offset:1024
  v_mfma_f32_32x32x16_bf16 v[80:95], v[24:27], v[12:15], v[80:95]
  ds_read_b128 v[16:19], v7 offset:1024
  s_waitcnt lgkmcnt(2)
  v_mfma_f32_32x32x16_bf16 v[96:111], v[28:31], v[8:11], v[96:111]
  ds_read_b128 v[20:23], v7 offset:3072
  v_mfma_f32_32x32x16_bf16 v[112:127], v[28:31], v[12:15], v[112:127]
  ds_read_b128 v[40:43], v6 offset:3072
  v_mfma_f32_32x32x16_bf16 v[128:143], v[32:35], v[8:11], v[128:143]
  ds_read_b128 v[44:47], v6 offset:5120
  v_mfma_f32_32x32x16_bf16 v[144:159], v[32:35], v[12:15], v[144:159]
  s_add_u32 s48, s48, 1
  s_and_b32 s48, s48, 7
  s_cselect_b32 s49, s50, s51
  s_add_u32 s47, s47, 1
  s_barrier
  v_add_u32 v7, s49, v7
  v_add_u32 v6, s49, v6
  s_cmp_lt_u32 s47, 15
  s_waitcnt lgkmcnt(2)
  v_mfma_f32_32x32x16_bf16 v[64:79], v[36:39], v[16:19], v[64:79]
  ds_read_b128 v[24:27], v6 offset:0
  v_mfma_f32_32x32x16_bf16 v[80:95], v[36:39], v[20:23], v[80:95]
  ds_read_b128 v[8:11], v7 offset:0
  s_waitcnt lgkmcnt(2)
  v_mfma_f32_32x32x16_bf16 v[96:111], v[40:43], v[16:19], v[96:111]
  ds_read_b128 v[12:15], v7 offset:2048
  v_mfma_f32_32x32x16_bf16 v[112:127], v[40:43], v[20:23], v[112:127]
  ds_read_b128 v[28:31], v6 offset:2048
  v_mfma_f32_32x32x16_bf16 v[128:143], v[44:47], v[16:19], v[128:143]
  ds_read_b128 v[32:35], v6 offset:4096
  v_mfma_f32_32x32x16_bf16 v[144:159], v[44:47], v[20:23], v[144:159]
  s_cbranch_scc1 sequential_preLN__softmax_full_mha__glu_gated_reglu__prompt_kernel_p4ml75
  s_add_u32 s33, s41, 0
  s_cmp_ge_u32 s33, 86
  s_cselect_b32 s33, 0x40000000, s40
  s_add_u32 s42, s33, 0
  s_add_u32 s43, s33, 88064
  s_add_u32 s33, s41, 1
  s_cmp_ge_u32 s33, 86
  s_cselect_b32 s33, 0x40000000, s40
  s_add_u32 s44, s33, 1024
  s_add_u32 s45, s33, 89088
  s_add_u32 s33, s41, 2
  s_cmp_ge_u32 s33, 86
  s_cselect_b32 s33, 0x40000000, s40
  s_add_u32 s46, s33, 2048
  s_add_u32 s47, s33, 90112
  ds_read_b128 v[36:39], v6 offset:1024
  ds_read_b128 v[16:19], v7 offset:1024
  ds_read_b128 v[20:23], v7 offset:3072
  ds_read_b128 v[40:43], v6 offset:3072
  ds_read_b128 v[44:47], v6 offset:5120
  s_waitcnt vmcnt(0) lgkmcnt(5)
  v_mfma_f32_32x32x16_bf16 v[64:79], v[24:27], v[8:11], v[64:79]
  v_add_f32 v48, v48, v49
  v_add_f32 v50, v50, v51
  v_add_f32 v52, v52, v53
  v_add_f32 v54, v54, v55
  v_add_f32 v48, v48, v50
  v_mfma_f32_32x32x16_bf16 v[80:95], v[24:27], v[12:15], v[80:95]
  v_add_f32 v52, v52, v54
  v_add_f32 v48, v48, v52
  v_mov_b32 v49, v48
  v_add_f32 v56, v56, v57
  v_add_f32 v58, v58, v59
  v_mfma_f32_32x32x16_bf16 v[96:111], v[28:31], v[8:11], v[96:111]
  v_add_f32 v60, v60, v61
  v_add_f32 v62, v62, v63
  v_add_f32 v56, v56, v58
  v_add_f32 v60, v60, v62
  v_add_f32 v56, v56, v60
  v_mfma_f32_32x32x16_bf16 v[112:127], v[28:31], v[12:15], v[112:127]
  v_mov_b32 v57, v56
  s_nop 0
  v_permlane32_swap_b32 v48, v49
  v_permlane32_swap_b32 v56, v57
  v_add_f32 v48, v48, v49
  s_waitcnt lgkmcnt(0)
  s_barrier
  v_mfma_f32_32x32x16_bf16 v[64:79], v[36:39], v[16:19], v[64:79]
  v_mov_b32 v49, 0x3727c5ac
  v_fmac_f32 v49, 0x3b000000, v48
  v_rcp_f32 v0, v49
  v_add_f32 v56, v56, v57
  v_mfma_f32_32x32x16_bf16 v[80:95], v[36:39], v[20:23], v[80:95]
  v_mov_b32 v57, 0x3727c5ac
  v_fmac_f32 v57, 0x3b000000, v56
  v_rcp_f32 v4, v57
  v_mfma_f32_32x32x16_bf16 v[128:143], v[32:35], v[8:11], v[128:143]
  v_mfma_f32_32x32x16_bf16 v[144:159], v[32:35], v[12:15], v[144:159]
  s_nop 2
  v_mfma_f32_32x32x16_bf16 v[96:111], v[40:43], v[16:19], v[96:111]
  v_max_f32 v64, 0, v64
  v_max_f32 v65, 0, v65
  v_max_f32 v66, 0, v66
  v_max_f32 v67, 0, v67
  v_max_f32 v68, 0, v68
  v_max_f32 v69, 0, v69
  v_mfma_f32_32x32x16_bf16 v[112:127], v[40:43], v[20:23], v[112:127]
  v_max_f32 v70, 0, v70
  v_max_f32 v71, 0, v71
  v_mul_f32 v72, v72, v0
  v_mul_f32 v73, v73, v0
  v_mul_f32 v74, v74, v0
  v_mul_f32 v75, v75, v0
  v_mfma_f32_32x32x16_bf16 v[128:143], v[44:47], v[16:19], v[128:143]
  v_mul_f32 v76, v76, v0
  v_mul_f32 v77, v77, v0
  v_mul_f32 v78, v78, v0
  v_mul_f32 v79, v79, v0
  v_mul_f32 v64, v64, v72
  v_mul_f32 v65, v65, v73
  v_mfma_f32_32x32x16_bf16 v[144:159], v[44:47], v[20:23], v[144:159]
  v_mul_f32 v66, v66, v74
  v_mul_f32 v67, v67, v75
  v_mul_f32 v68, v68, v76
  v_mul_f32 v69, v69, v77
  v_mul_f32 v70, v70, v78
  v_mul_f32 v71, v71, v79
  v_cvt_pk_bf16_f32 v48, v64, v65
  v_cvt_pk_bf16_f32 v49, v66, v67
  v_cvt_pk_bf16_f32 v50, v68, v69
  v_cvt_pk_bf16_f32 v51, v70, v71
  buffer_store_dwordx4 v[48:51], v3, s[20:23], s42 offen sc1
  v_max_f32 v80, 0, v80
  v_max_f32 v81, 0, v81
  v_max_f32 v82, 0, v82
  v_max_f32 v83, 0, v83
  v_max_f32 v84, 0, v84
  v_max_f32 v85, 0, v85
  v_max_f32 v86, 0, v86
  v_max_f32 v87, 0, v87
  v_mul_f32 v88, v88, v4
  v_mul_f32 v89, v89, v4
  v_mul_f32 v90, v90, v4
  v_mul_f32 v91, v91, v4
  v_mul_f32 v92, v92, v4
  v_mul_f32 v93, v93, v4
  v_mul_f32 v94, v94, v4
  v_mul_f32 v95, v95, v4
  v_mul_f32 v80, v80, v88
  v_mul_f32 v81, v81, v89
  v_mul_f32 v82, v82, v90
  v_mul_f32 v83, v83, v91
  v_mul_f32 v84, v84, v92
  v_mul_f32 v85, v85, v93
  v_mul_f32 v86, v86, v94
  v_mul_f32 v87, v87, v95
  v_cvt_pk_bf16_f32 v52, v80, v81
  v_cvt_pk_bf16_f32 v53, v82, v83
  v_cvt_pk_bf16_f32 v54, v84, v85
  v_cvt_pk_bf16_f32 v55, v86, v87
  buffer_store_dwordx4 v[52:55], v3, s[20:23], s43 offen sc1
  v_max_f32 v96, 0, v96
  v_max_f32 v97, 0, v97
  v_max_f32 v98, 0, v98
  v_max_f32 v99, 0, v99
  v_max_f32 v100, 0, v100
  v_max_f32 v101, 0, v101
  v_max_f32 v102, 0, v102
  v_max_f32 v103, 0, v103
  v_pk_mul_f32 v[104:105], v[104:105], v[0:1] op_sel_hi:[1,0]
  v_pk_mul_f32 v[106:107], v[106:107], v[0:1] op_sel_hi:[1,0]
  v_pk_mul_f32 v[108:109], v[108:109], v[0:1] op_sel_hi:[1,0]
  v_pk_mul_f32 v[110:111], v[110:111], v[0:1] op_sel_hi:[1,0]
  v_pk_mul_f32 v[96:97], v[96:97], v[104:105]
  v_pk_mul_f32 v[98:99], v[98:99], v[106:107]
  v_pk_mul_f32 v[100:101], v[100:101], v[108:109]
  v_pk_mul_f32 v[102:103], v[102:103], v[110:111]
  v_cvt_pk_bf16_f32 v56, v96, v97
  v_cvt_pk_bf16_f32 v57, v98, v99
  v_cvt_pk_bf16_f32 v58, v100, v101
  v_cvt_pk_bf16_f32 v59, v102, v103
  buffer_store_dwordx4 v[56:59], v3, s[20:23], s44 offen sc1
  v_max_f32 v112, 0, v112
  v_max_f32 v113, 0, v113
  v_max_f32 v114, 0, v114
  v_max_f32 v115, 0, v115
  v_max_f32 v116, 0, v116
  v_max_f32 v117, 0, v117
  v_max_f32 v118, 0, v118
  v_max_f32 v119, 0, v119
  v_pk_mul_f32 v[120:121], v[120:121], v[4:5] op_sel_hi:[1,0]
  v_pk_mul_f32 v[122:123], v[122:123], v[4:5] op_sel_hi:[1,0]
  v_pk_mul_f32 v[124:125], v[124:125], v[4:5] op_sel_hi:[1,0]
  v_pk_mul_f32 v[126:127], v[126:127], v[4:5] op_sel_hi:[1,0]
  v_pk_mul_f32 v[112:113], v[112:113], v[120:121]
  v_pk_mul_f32 v[114:115], v[114:115], v[122:123]
  v_pk_mul_f32 v[116:117], v[116:117], v[124:125]
  v_pk_mul_f32 v[118:119], v[118:119], v[126:127]
  v_cvt_pk_bf16_f32 v60, v112, v113
  v_cvt_pk_bf16_f32 v61, v114, v115
  v_cvt_pk_bf16_f32 v62, v116, v117
  v_cvt_pk_bf16_f32 v63, v118, v119
  buffer_store_dwordx4 v[60:63], v3, s[20:23], s45 offen sc1
  v_max_f32 v128, 0, v128
  v_max_f32 v129, 0, v129
  v_max_f32 v130, 0, v130
  v_max_f32 v131, 0, v131
  v_max_f32 v132, 0, v132
  v_max_f32 v133, 0, v133
  v_max_f32 v134, 0, v134
  v_max_f32 v135, 0, v135
  v_pk_mul_f32 v[136:137], v[136:137], v[0:1] op_sel_hi:[1,0]
  v_pk_mul_f32 v[138:139], v[138:139], v[0:1] op_sel_hi:[1,0]
  v_pk_mul_f32 v[140:141], v[140:141], v[0:1] op_sel_hi:[1,0]
  v_pk_mul_f32 v[142:143], v[142:143], v[0:1] op_sel_hi:[1,0]
  v_pk_mul_f32 v[128:129], v[128:129], v[136:137]
  v_pk_mul_f32 v[130:131], v[130:131], v[138:139]
  v_pk_mul_f32 v[132:133], v[132:133], v[140:141]
  v_pk_mul_f32 v[134:135], v[134:135], v[142:143]
  v_cvt_pk_bf16_f32 v8, v128, v129
  v_cvt_pk_bf16_f32 v9, v130, v131
  v_cvt_pk_bf16_f32 v10, v132, v133
  v_cvt_pk_bf16_f32 v11, v134, v135
  buffer_store_dwordx4 v[8:11], v3, s[20:23], s46 offen sc1
  v_max_f32 v144, 0, v144
  v_max_f32 v145, 0, v145
  v_max_f32 v146, 0, v146
  v_max_f32 v147, 0, v147
  v_max_f32 v148, 0, v148
  v_max_f32 v149, 0, v149
  v_max_f32 v150, 0, v150
  v_max_f32 v151, 0, v151
  v_pk_mul_f32 v[152:153], v[152:153], v[4:5] op_sel_hi:[1,0]
  v_pk_mul_f32 v[154:155], v[154:155], v[4:5] op_sel_hi:[1,0]
  v_pk_mul_f32 v[156:157], v[156:157], v[4:5] op_sel_hi:[1,0]
  v_pk_mul_f32 v[158:159], v[158:159], v[4:5] op_sel_hi:[1,0]
  v_pk_mul_f32 v[144:145], v[144:145], v[152:153]
  v_pk_mul_f32 v[146:147], v[146:147], v[154:155]
  v_pk_mul_f32 v[148:149], v[148:149], v[156:157]
  v_pk_mul_f32 v[150:151], v[150:151], v[158:159]
  v_cvt_pk_bf16_f32 v12, v144, v145
  v_cvt_pk_bf16_f32 v13, v146, v147
  v_cvt_pk_bf16_f32 v14, v148, v149
  v_cvt_pk_bf16_f32 v15, v150, v151
  buffer_store_dwordx4 v[12:15], v3, s[20:23], s47 offen sc1
sequential_preLN__softmax_full_mha__glu_gated_reglu__prompt_kernel_p4fin74:
  s_waitcnt vmcnt(0)
  s_barrier
  s_branch sequential_preLN__softmax_full_mha__glu_gated_reglu__prompt_kernel_p4j76
sequential_preLN__softmax_full_mha__glu_gated_reglu__prompt_kernel_p4skip73:
  s_barrier
sequential_preLN__softmax_full_mha__glu_gated_reglu__prompt_kernel_p4j76:
  s_lshl_b32 s27, s24, 2
  s_and_b32 s28, s25, 3
  s_add_u32 s27, s27, s28
  s_lshr_b32 s28, s25, 2
  s_and_b32 s29, s26, 1
  s_lshl_b32 s30, s27, 1
  s_add_u32 s30, s30, s29
  s_lshr_b32 s31, s26, 1
  s_lshl_b32 s32, s28, 1
  s_add_u32 s32, s32, s31
  s_mul_i32 s33, s31, 3072
  v_add_u32 v6, s33, v3
  s_lshl_b32 s33, s31, 10
  s_add_u32 s33, s33, 1024
  v_add_u32 v7, s33, v3
  s_mul_i32 s34, s31, 43
  s_mul_i32 s35, s30, 86
  s_add_u32 s35, s35, s34
  s_lshl_b32 s35, s35, 10
  s_add_u32 s35, s35, 12582912
  s_xor_b32 s36, s32, 0
  s_mul_i32 s36, s36, 86
  s_add_u32 s36, s36, s34
  s_lshl_b32 s36, s36, 10
  s_add_u32 s36, s36, 23108608
  buffer_load_dwordx4 v[80:83], v3, s[20:23], s36 offen sc1
  buffer_load_dwordx4 v[88:91], v3, s[20:23], s36 offen offset:1024 sc1
  buffer_load_dwordx4 v[96:99], v3, s[20:23], s36 offen offset:2048 sc1
  buffer_load_dwordx4 v[104:107], v3, s[20:23], s36 offen offset:3072 sc1
  s_xor_b32 s36, s32, 1
  s_mul_i32 s36, s36, 86
  s_add_u32 s36, s36, s34
  s_lshl_b32 s36, s36, 10
  s_add_u32 s36, s36, 23108608
  buffer_load_dwordx4 v[84:87], v3, s[20:23], s36 offen sc1
  buffer_load_dwordx4 v[92:95], v3, s[20:23], s36 offen offset:1024 sc1
  buffer_load_dwordx4 v[100:103], v3, s[20:23], s36 offen offset:2048 sc1
  buffer_load_dwordx4 v[108:111], v3, s[20:23], s36 offen offset:3072 sc1
  s_mov_b32 s52, s18
  s_and_b32 s53, s19, 0xffff
  s_mov_b32 s54, 2097152
  s_mov_b32 s55, 0x20000
  v_and_b32 v8, 31, v2
  v_lshlrev_b32 v8, 10, v8
  v_lshrrev_b32 v9, 5, v2
  v_lshl_add_u32 v8, v9, 4, v8
  s_lshl_b32 s47, s30, 15
  s_lshl_b32 s48, s32, 6
  s_add_u32 s47, s47, s48
  s_lshl_b32 s36, s31, 2
  v_add_u32 v10, s36, v9
  v_and_b32 v12, 7, v2
  v_xor_b32 v10, v10, v12
  v_xor_b32 v11, 2, v10
  v_and_b32 v13, 31, v2
  s_lshl_b32 s36, s29, 12
  s_add_u32 s36, s36, 32768
  v_lshl_add_u32 v13, v13, 7, s36
  v_lshl_add_u32 v10, v10, 4, v13
  v_lshl_add_u32 v11, v11, 4, v13
  v_lshrrev_b32 v13, 3, v2
  v_xor_b32 v14, v12, v13
  v_lshlrev_b32 v14, 4, v14
  v_lshl_add_u32 v13, v13, 10, v14
  s_lshl_b32 s36, s26, 11
  s_add_u32 s36, s36, 32768
  v_add_u32 v12, s36, v3
  s_lshl_b32 s47, s27, 16
  s_lshl_b32 s48, s26, 14
  s_add_u32 s47, s47, s48
  s_lshl_b32 s48, s28, 7
  s_add_u32 s47, s47, s48
  s_xor_b32 s36, s26, 2
  s_lshl_b32 s36, s36, 12
  v_add_u32 v4, s36, v3
  s_lshl_b32 s36, s26, 12
  v_add_u32 v5, s36, v3
  s_mov_b32 s45, 0xffff0000
  v_lshlrev_b32 v16, 16, v160
  v_and_b32 v17, s45, v160
  v_lshlrev_b32 v18, 16, v161
  v_and_b32 v19, s45, v161
  v_lshlrev_b32 v20, 16, v162
  v_and_b32 v21, s45, v162
  v_lshlrev_b32 v22, 16, v163
  v_and_b32 v23, s45, v163
  v_lshlrev_b32 v24, 16, v164
  v_and_b32 v25, s45, v164
  v_lshlrev_b32 v26, 16, v165
  v_and_b32 v27, s45, v165
  v_lshlrev_b32 v28, 16, v166
  v_and_b32 v29, s45, v166
  v_lshlrev_b32 v30, 16, v167
  v_and_b32 v31, s45, v167
  s_barrier
  s_add_u32 s36, s35, 0
  buffer_load_dwordx4 v[112:115], v3, s[20:23], s36 offen sc1
  buffer_load_dwordx4 v[116:119], v3, s[20:23], s36 offen offset:1024 sc1
  buffer_load_dwordx4 v[120:123], v3, s[20:23], s36 offen offset:2048 sc1
  buffer_load_dwordx4 v[124:127], v3, s[20:23], s36 offen offset:3072 sc1
  s_add_u32 s36, s35, 4096
  buffer_load_dwordx4 v[128:131], v3, s[20:23], s36 offen sc1
  buffer_load_dwordx4 v[132:135], v3, s[20:23], s36 offen offset:1024 sc1
  buffer_load_dwordx4 v[136:139], v3, s[20:23], s36 offen offset:2048 sc1
  buffer_load_dwordx4 v[140:143], v3, s[20:23], s36 offen offset:3072 sc1
  s_add_u32 s36, s35, 8192
  buffer_load_dwordx4 v[144:147], v3, s[20:23], s36 offen sc1
  buffer_load_dwordx4 v[148:151], v3, s[20:23], s36 offen offset:1024 sc1
  buffer_load_dwordx4 v[152:155], v3, s[20:23], s36 offen offset:2048 sc1
  buffer_load_dwordx4 v[156:159], v3, s[20:23], s36 offen offset:3072 sc1
  ds_read_b128 v[48:51], v6 offset:0
  ds_read_b128 v[52:55], v7 offset:0
  ds_read_b128 v[56:59], v6 offset:4096
  ds_read_b128 v[60:63], v7 offset:4096
  ds_read_b128 v[64:67], v6 offset:8192
  ds_read_b128 v[68:71], v7 offset:8192
  s_waitcnt vmcnt(11) lgkmcnt(4)
  v_mfma_f32_32x32x16_bf16 v[16:31], v[48:51], v[112:115], v[16:31]
  ds_read_b128 v[72:75], v6 offset:12288
  v_mfma_f32_32x32x16_bf16 v[32:47], v[52:55], v[112:115], 0
  ds_read_b128 v[76:79], v7 offset:12288
  s_add_u32 s36, s35, 12288
  buffer_load_dwordx4 v[112:115], v3, s[20:23], s36 offen sc1
  s_waitcnt vmcnt(11) lgkmcnt(4)
  v_mfma_f32_32x32x16_bf16 v[16:31], v[56:59], v[116:119], v[16:31]
  ds_read_b128 v[48:51], v6 offset:16384
  v_mfma_f32_32x32x16_bf16 v[32:47], v[60:63], v[116:119], v[32:47]
  ds_read_b128 v[52:55], v7 offset:16384
  buffer_load_dwordx4 v[116:119], v3, s[20:23], s36 offen offset:1024 sc1
  s_waitcnt vmcnt(11) lgkmcnt(4)
  v_mfma_f32_32x32x16_bf16 v[16:31], v[64:67], v[120:123], v[16:31]
  ds_read_b128 v[56:59], v6 offset:20480
  v_mfma_f32_32x32x16_bf16 v[32:47], v[68:71], v[120:123], v[32:47]
  ds_read_b128 v[60:63], v7 offset:20480
  buffer_load_dwordx4 v[120:123], v3, s[20:23], s36 offen offset:2048 sc1
  s_waitcnt vmcnt(11) lgkmcnt(4)
  v_mfma_f32_32x32x16_bf16 v[16:31], v[72:75], v[124:127], v[16:31]
  ds_read_b128 v[64:67], v6 offset:24576
  v_mfma_f32_32x32x16_bf16 v[32:47], v[76:79], v[124:127], v[32:47]
  ds_read_b128 v[68:71], v7 offset:24576
  buffer_load_dwordx4 v[124:127], v3, s[20:23], s36 offen offset:3072 sc1
  s_waitcnt vmcnt(11) lgkmcnt(4)
  v_mfma_f32_32x32x16_bf16 v[16:31], v[48:51], v[128:131], v[16:31]
  ds_read_b128 v[72:75], v6 offset:28672
  v_mfma_f32_32x32x16_bf16 v[32:47], v[52:55], v[128:131], v[32:47]
  ds_read_b128 v[76:79], v7 offset:28672
  s_add_u32 s36, s35, 16384
  buffer_load_dwordx4 v[128:131], v3, s[20:23], s36 offen sc1
  s_waitcnt vmcnt(11) lgkmcnt(4)
  v_mfma_f32_32x32x16_bf16 v[16:31], v[56:59], v[132:135], v[16:31]
  ds_read_b128 v[48:51], v6 offset:32768
  v_mfma_f32_32x32x16_bf16 v[32:47], v[60:63], v[132:135], v[32:47]
  ds_read_b128 v[52:55], v7 offset:32768
  buffer_load_dwordx4 v[132:135], v3, s[20:23], s36 offen offset:1024 sc1
  s_waitcnt vmcnt(11) lgkmcnt(4)
  v_mfma_f32_32x32x16_bf16 v[16:31], v[64:67], v[136:139], v[16:31]
  ds_read_b128 v[56:59], v6 offset:36864
  v_mfma_f32_32x32x16_bf16 v[32:47], v[68:71], v[136:139], v[32:47]
  ds_read_b128 v[60:63], v7 offset:36864
  buffer_load_dwordx4 v[136:139], v3, s[20:23], s36 offen offset:2048 sc1
  s_waitcnt vmcnt(11) lgkmcnt(4)
  v_mfma_f32_32x32x16_bf16 v[16:31], v[72:75], v[140:143], v[16:31]
  ds_read_b128 v[64:67], v6 offset:40960
  v_mfma_f32_32x32x16_bf16 v[32:47], v[76:79], v[140:143], v[32:47]
  ds_read_b128 v[68:71], v7 offset:40960
  buffer_load_dwordx4 v[140:143], v3, s[20:23], s36 offen offset:3072 sc1
  s_waitcnt vmcnt(11) lgkmcnt(4)
  v_mfma_f32_32x32x16_bf16 v[16:31], v[48:51], v[144:147], v[16:31]
  ds_read_b128 v[72:75], v6 offset:45056
  v_mfma_f32_32x32x16_bf16 v[32:47], v[52:55], v[144:147], v[32:47]
  ds_read_b128 v[76:79], v7 offset:45056
  s_add_u32 s36, s35, 20480
  buffer_load_dwordx4 v[144:147], v3, s[20:23], s36 offen sc1
  s_waitcnt vmcnt(11) lgkmcnt(4)
  v_mfma_f32_32x32x16_bf16 v[16:31], v[56:59], v[148:151], v[16:31]
  ds_read_b128 v[48:51], v6 offset:49152
  v_mfma_f32_32x32x16_bf16 v[32:47], v[60:63], v[148:151], v[32:47]
  ds_read_b128 v[52:55], v7 offset:49152
  buffer_load_dwordx4 v[148:151], v3, s[20:23], s36 offen offset:1024 sc1
  s_waitcnt vmcnt(11) lgkmcnt(4)
  v_mfma_f32_32x32x16_bf16 v[16:31], v[64:67], v[152:155], v[16:31]
  ds_read_b128 v[56:59], v6 offset:53248
  v_mfma_f32_32x32x16_bf16 v[32:47], v[68:71], v[152:155], v[32:47]
  ds_read_b128 v[60:63], v7 offset:53248
  buffer_load_dwordx4 v[152:155], v3, s[20:23], s36 offen offset:2048 sc1
  s_waitcnt vmcnt(11) lgkmcnt(4)
  v_mfma_f32_32x32x16_bf16 v[16:31], v[72:75], v[156:159], v[16:31]
  ds_read_b128 v[64:67], v6 offset:57344
  v_mfma_f32_32x32x16_bf16 v[32:47], v[76:79], v[156:159], v[32:47]
  ds_read_b128 v[68:71], v7 offset:57344
  buffer_load_dwordx4 v[156:159], v3, s[20:23], s36 offen offset:3072 sc1
  s_waitcnt vmcnt(11) lgkmcnt(4)
  v_mfma_f32_32x32x16_bf16 v[16:31], v[48:51], v[112:115], v[16:31]
  ds_read_b128 v[72:75], v6 offset:61440
  v_mfma_f32_32x32x16_bf16 v[32:47], v[52:55], v[112:115], v[32:47]
  ds_read_b128 v[76:79], v7 offset:61440
  s_add_u32 s36, s35, 24576
  buffer_load_dwordx4 v[112:115], v3, s[20:23], s36 offen sc1
  s_waitcnt vmcnt(11) lgkmcnt(4)
  v_mfma_f32_32x32x16_bf16 v[16:31], v[56:59], v[116:119], v[16:31]
  v_add_u32 v6, 65536, v6
  v_add_u32 v7, 65536, v7
  ds_read_b128 v[48:51], v6 offset:0
  v_mfma_f32_32x32x16_bf16 v[32:47], v[60:63], v[116:119], v[32:47]
  ds_read_b128 v[52:55], v7 offset:0
  buffer_load_dwordx4 v[116:119], v3, s[20:23], s36 offen offset:1024 sc1
  s_waitcnt vmcnt(11) lgkmcnt(4)
  v_mfma_f32_32x32x16_bf16 v[16:31], v[64:67], v[120:123], v[16:31]
  ds_read_b128 v[56:59], v6 offset:4096
  v_mfma_f32_32x32x16_bf16 v[32:47], v[68:71], v[120:123], v[32:47]
  ds_read_b128 v[60:63], v7 offset:4096
  buffer_load_dwordx4 v[120:123], v3, s[20:23], s36 offen offset:2048 sc1
  s_waitcnt vmcnt(11) lgkmcnt(4)
  v_mfma_f32_32x32x16_bf16 v[16:31], v[72:75], v[124:127], v[16:31]
  ds_read_b128 v[64:67], v6 offset:8192
  v_mfma_f32_32x32x16_bf16 v[32:47], v[76:79], v[124:127], v[32:47]
  ds_read_b128 v[68:71], v7 offset:8192
  buffer_load_dwordx4 v[124:127], v3, s[20:23], s36 offen offset:3072 sc1
  s_waitcnt vmcnt(11) lgkmcnt(4)
  v_mfma_f32_32x32x16_bf16 v[16:31], v[48:51], v[128:131], v[16:31]
  ds_read_b128 v[72:75], v6 offset:12288
  v_mfma_f32_32x32x16_bf16 v[32:47], v[52:55], v[128:131], v[32:47]
  ds_read_b128 v[76:79], v7 offset:12288
  s_add_u32 s36, s35, 28672
  buffer_load_dwordx4 v[128:131], v3, s[20:23], s36 offen sc1
  s_waitcnt vmcnt(11) lgkmcnt(4)
  v_mfma_f32_32x32x16_bf16 v[16:31], v[56:59], v[132:135], v[16:31]
  ds_read_b128 v[48:51], v6 offset:16384
  v_mfma_f32_32x32x16_bf16 v[32:47], v[60:63], v[132:135], v[32:47]
  ds_read_b128 v[52:55], v7 offset:16384
  buffer_load_dwordx4 v[132:135], v3, s[20:23], s36 offen offset:1024 sc1
  s_waitcnt vmcnt(11) lgkmcnt(4)
  v_mfma_f32_32x32x16_bf16 v[16:31], v[64:67], v[136:139], v[16:31]
  ds_read_b128 v[56:59], v6 offset:20480
  v_mfma_f32_32x32x16_bf16 v[32:47], v[68:71], v[136:139], v[32:47]
  ds_read_b128 v[60:63], v7 offset:20480
  buffer_load_dwordx4 v[136:139], v3, s[20:23], s36 offen offset:2048 sc1
  s_waitcnt vmcnt(11) lgkmcnt(4)
  v_mfma_f32_32x32x16_bf16 v[16:31], v[72:75], v[140:143], v[16:31]
  ds_read_b128 v[64:67], v6 offset:24576
  v_mfma_f32_32x32x16_bf16 v[32:47], v[76:79], v[140:143], v[32:47]
  ds_read_b128 v[68:71], v7 offset:24576
  buffer_load_dwordx4 v[140:143], v3, s[20:23], s36 offen offset:3072 sc1
  s_waitcnt vmcnt(11) lgkmcnt(4)
  v_mfma_f32_32x32x16_bf16 v[16:31], v[48:51], v[144:147], v[16:31]
  ds_read_b128 v[72:75], v6 offset:28672
  v_mfma_f32_32x32x16_bf16 v[32:47], v[52:55], v[144:147], v[32:47]
  ds_read_b128 v[76:79], v7 offset:28672
  s_add_u32 s36, s35, 32768
  buffer_load_dwordx4 v[144:147], v3, s[20:23], s36 offen sc1
  s_waitcnt vmcnt(11) lgkmcnt(4)
  v_mfma_f32_32x32x16_bf16 v[16:31], v[56:59], v[148:151], v[16:31]
  ds_read_b128 v[48:51], v6 offset:32768
  v_mfma_f32_32x32x16_bf16 v[32:47], v[60:63], v[148:151], v[32:47]
  ds_read_b128 v[52:55], v7 offset:32768
  buffer_load_dwordx4 v[148:151], v3, s[20:23], s36 offen offset:1024 sc1
  s_waitcnt vmcnt(11) lgkmcnt(4)
  v_mfma_f32_32x32x16_bf16 v[16:31], v[64:67], v[152:155], v[16:31]
  s_barrier
  ds_read_b128 v[56:59], v6 offset:36864
  v_mfma_f32_32x32x16_bf16 v[32:47], v[68:71], v[152:155], v[32:47]
  ds_read_b128 v[60:63], v7 offset:36864
  buffer_load_dwordx4 v[152:155], v3, s[20:23], s36 offen offset:2048 sc1
  s_waitcnt vmcnt(11) lgkmcnt(4)
  v_mfma_f32_32x32x16_bf16 v[16:31], v[72:75], v[156:159], v[16:31]
  ds_read_b128 v[64:67], v6 offset:40960
  v_mfma_f32_32x32x16_bf16 v[32:47], v[76:79], v[156:159], v[32:47]
  ds_read_b128 v[68:71], v7 offset:40960
  buffer_load_dwordx4 v[156:159], v3, s[20:23], s36 offen offset:3072 sc1
  s_waitcnt vmcnt(11) lgkmcnt(4)
  v_mfma_f32_32x32x16_bf16 v[16:31], v[48:51], v[112:115], v[16:31]
  ds_read_b128 v[72:75], v6 offset:45056
  v_mfma_f32_32x32x16_bf16 v[32:47], v[52:55], v[112:115], v[32:47]
  ds_read_b128 v[76:79], v7 offset:45056
  s_add_u32 s36, s35, 36864
  buffer_load_dwordx4 v[112:115], v3, s[20:23], s36 offen sc1
  s_waitcnt vmcnt(11) lgkmcnt(4)
  v_mfma_f32_32x32x16_bf16 v[16:31], v[56:59], v[116:119], v[16:31]
  ds_read_b128 v[48:51], v6 offset:49152
  v_mfma_f32_32x32x16_bf16 v[32:47], v[60:63], v[116:119], v[32:47]
  ds_read_b128 v[52:55], v7 offset:49152
  buffer_load_dwordx4 v[116:119], v3, s[20:23], s36 offen offset:1024 sc1
  s_waitcnt vmcnt(11) lgkmcnt(4)
  v_mfma_f32_32x32x16_bf16 v[16:31], v[64:67], v[120:123], v[16:31]
  ds_read_b128 v[56:59], v6 offset:53248
  v_mfma_f32_32x32x16_bf16 v[32:47], v[68:71], v[120:123], v[32:47]
  ds_read_b128 v[60:63], v7 offset:53248
  buffer_load_dwordx4 v[120:123], v3, s[20:23], s36 offen offset:2048 sc1
  s_waitcnt vmcnt(11) lgkmcnt(4)
  v_mfma_f32_32x32x16_bf16 v[16:31], v[72:75], v[124:127], v[16:31]
  ds_read_b128 v[64:67], v6 offset:57344
  v_mfma_f32_32x32x16_bf16 v[32:47], v[76:79], v[124:127], v[32:47]
  ds_read_b128 v[68:71], v7 offset:57344
  buffer_load_dwordx4 v[124:127], v3, s[20:23], s36 offen offset:3072 sc1
  s_waitcnt vmcnt(11) lgkmcnt(4)
  v_mfma_f32_32x32x16_bf16 v[16:31], v[48:51], v[128:131], v[16:31]
  ds_read_b128 v[72:75], v6 offset:61440
  v_mfma_f32_32x32x16_bf16 v[32:47], v[52:55], v[128:131], v[32:47]
  ds_read_b128 v[76:79], v7 offset:61440
  s_add_u32 s36, s35, 40960
  buffer_load_dwordx4 v[128:131], v3, s[20:23], s36 offen sc1
  s_waitcnt vmcnt(11) lgkmcnt(4)
  v_mfma_f32_32x32x16_bf16 v[16:31], v[56:59], v[132:135], v[16:31]
  v_add_u32 v6, 65536, v6
  v_add_u32 v7, 65536, v7
  ds_read_b128 v[48:51], v6 offset:0
  v_mfma_f32_32x32x16_bf16 v[32:47], v[60:63], v[132:135], v[32:47]
  ds_read_b128 v[52:55], v7 offset:0
  buffer_load_dwordx4 v[132:135], v3, s[20:23], s36 offen offset:1024 sc1
  s_waitcnt vmcnt(11) lgkmcnt(4)
  v_mfma_f32_32x32x16_bf16 v[16:31], v[64:67], v[136:139], v[16:31]
  ds_read_b128 v[56:59], v6 offset:4096
  v_mfma_f32_32x32x16_bf16 v[32:47], v[68:71], v[136:139], v[32:47]
  ds_read_b128 v[60:63], v7 offset:4096
  buffer_load_dwordx4 v[136:139], v3, s[20:23], s36 offen offset:2048 sc1
  s_waitcnt vmcnt(11) lgkmcnt(4)
  v_mfma_f32_32x32x16_bf16 v[16:31], v[72:75], v[140:143], v[16:31]
  ds_read_b128 v[64:67], v6 offset:8192
  v_mfma_f32_32x32x16_bf16 v[32:47], v[76:79], v[140:143], v[32:47]
  ds_read_b128 v[68:71], v7 offset:8192
  s_waitcnt vmcnt(10) lgkmcnt(4)
  v_mfma_f32_32x32x16_bf16 v[16:31], v[48:51], v[144:147], v[16:31]
  ds_read_b128 v[72:75], v6 offset:12288
  v_mfma_f32_32x32x16_bf16 v[32:47], v[52:55], v[144:147], v[32:47]
  ds_read_b128 v[76:79], v7 offset:12288
  s_waitcnt vmcnt(9) lgkmcnt(4)
  v_mfma_f32_32x32x16_bf16 v[16:31], v[56:59], v[148:151], v[16:31]
  ds_read_b128 v[48:51], v6 offset:16384
  v_mfma_f32_32x32x16_bf16 v[32:47], v[60:63], v[148:151], v[32:47]
  ds_read_b128 v[52:55], v7 offset:16384
  s_waitcnt vmcnt(8) lgkmcnt(4)
  v_mfma_f32_32x32x16_bf16 v[16:31], v[64:67], v[152:155], v[16:31]
  ds_read_b128 v[56:59], v6 offset:20480
  v_mfma_f32_32x32x16_bf16 v[32:47], v[68:71], v[152:155], v[32:47]
  ds_read_b128 v[60:63], v7 offset:20480
  s_waitcnt vmcnt(7) lgkmcnt(4)
  v_mfma_f32_32x32x16_bf16 v[16:31], v[72:75], v[156:159], v[16:31]
  ds_read_b128 v[64:67], v6 offset:24576
  v_mfma_f32_32x32x16_bf16 v[32:47], v[76:79], v[156:159], v[32:47]
  ds_read_b128 v[68:71], v7 offset:24576
  s_waitcnt vmcnt(6) lgkmcnt(4)
  v_mfma_f32_32x32x16_bf16 v[16:31], v[48:51], v[112:115], v[16:31]
  v_mfma_f32_32x32x16_bf16 v[32:47], v[52:55], v[112:115], v[32:47]
  s_waitcnt vmcnt(5) lgkmcnt(2)
  v_mfma_f32_32x32x16_bf16 v[16:31], v[56:59], v[116:119], v[16:31]
  v_mfma_f32_32x32x16_bf16 v[32:47], v[60:63], v[116:119], v[32:47]
  s_waitcnt vmcnt(4) lgkmcnt(0)
  v_mfma_f32_32x32x16_bf16 v[16:31], v[64:67], v[120:123], v[16:31]
  v_mfma_f32_32x32x16_bf16 v[32:47], v[68:71], v[120:123], v[32:47]
  s_waitcnt vmcnt(3)
  v_mfma_f32_32x32x16_bf16 v[16:31], v[80:83], v[124:127], v[16:31]
  v_mfma_f32_32x32x16_bf16 v[32:47], v[84:87], v[124:127], v[32:47]
  s_waitcnt vmcnt(2)
  v_mfma_f32_32x32x16_bf16 v[16:31], v[88:91], v[128:131], v[16:31]
  v_mfma_f32_32x32x16_bf16 v[32:47], v[92:95], v[128:131], v[32:47]
  s_waitcnt vmcnt(1)
  v_mfma_f32_32x32x16_bf16 v[16:31], v[96:99], v[132:135], v[16:31]
  v_mfma_f32_32x32x16_bf16 v[32:47], v[100:103], v[132:135], v[32:47]
  s_waitcnt vmcnt(0)
  v_mfma_f32_32x32x16_bf16 v[32:47], v[108:111], v[136:139], v[32:47]
  v_mfma_f32_32x32x16_bf16 v[16:31], v[104:107], v[136:139], v[16:31]
  s_nop 9
  s_barrier
  ds_write_b128 v4, v[32:35] offset:0
  ds_write_b128 v4, v[36:39] offset:1024
  ds_write_b128 v4, v[40:43] offset:2048
  ds_write_b128 v4, v[44:47] offset:3072
  s_waitcnt lgkmcnt(0)
  s_barrier
  ds_read_b128 v[48:51], v5 offset:0
  ds_read_b128 v[52:55], v5 offset:1024
  ds_read_b128 v[56:59], v5 offset:2048
  ds_read_b128 v[60:63], v5 offset:3072
  s_waitcnt lgkmcnt(3)
  v_pk_add_f32 v[16:17], v[16:17], v[48:49]
  v_pk_add_f32 v[18:19], v[18:19], v[50:51]
  v_cvt_pk_bf16_f32 v64, v16, v17
  v_cvt_pk_bf16_f32 v65, v18, v19
  s_waitcnt lgkmcnt(2)
  v_pk_add_f32 v[20:21], v[20:21], v[52:53]
  v_pk_add_f32 v[22:23], v[22:23], v[54:55]
  v_cvt_pk_bf16_f32 v66, v20, v21
  v_cvt_pk_bf16_f32 v67, v22, v23
  s_waitcnt lgkmcnt(1)
  v_pk_add_f32 v[24:25], v[24:25], v[56:57]
  v_pk_add_f32 v[26:27], v[26:27], v[58:59]
  v_cvt_pk_bf16_f32 v68, v24, v25
  v_cvt_pk_bf16_f32 v69, v26, v27
  s_waitcnt lgkmcnt(0)
  v_pk_add_f32 v[28:29], v[28:29], v[60:61]
  v_pk_add_f32 v[30:31], v[30:31], v[62:63]
  v_cvt_pk_bf16_f32 v70, v28, v29
  v_cvt_pk_bf16_f32 v71, v30, v31
  s_nop 1
  v_permlane32_swap_b32 v64, v66
  v_permlane32_swap_b32 v65, v67
  v_permlane32_swap_b32 v68, v70
  v_permlane32_swap_b32 v69, v71
  ds_write_b128 v10, v[64:67]
  ds_write_b128 v11, v[68:71]
  s_waitcnt lgkmcnt(0)
  s_barrier
  ds_read_b128 v[64:67], v12
  ds_read_b128 v[68:71], v12 offset:1024
  s_waitcnt lgkmcnt(1)
  buffer_store_dwordx4 v[64:67], v13, s[52:55], s47 offen
  s_add_u32 s47, s47, 8192
  s_waitcnt lgkmcnt(0)
  buffer_store_dwordx4 v[68:71], v13, s[52:55], s47 offen
sequential_preLN__softmax_full_mha__glu_gated_reglu__prompt_kernel_done1:
  s_endpgm
sequential_preLN__softmax_full_mha__glu_gated_reglu__prompt_kernel_L372:
  s_sub_u32 s45, s26, 4
  s_lshr_b32 s44, s25, 2
  s_lshl_b32 s44, s44, 1
  s_and_b32 s46, s45, 1
  s_add_u32 s44, s44, s46
  s_mul_i32 s44, s44, 32
  s_lshr_b32 s46, s45, 1
  s_mul_i32 s46, s46, 16
  s_add_u32 s44, s44, s46
  s_lshl_b32 s44, s44, 10
  s_add_u32 s44, s44, 18874368
  s_lshl_b32 s45, s45, 10
  v_mov_b32 v4, 131092
  ds_read_b32 v4, v4
  s_add_u32 s46, s44, 7168
  s_add_u32 m0, s45, 12288
  s_nop 0
  buffer_load_dwordx4 v3, s[20:23], s46 offen sc1 lds
  s_add_u32 s46, s44, 8192
  s_add_u32 m0, s45, 16384
  s_nop 0
  buffer_load_dwordx4 v3, s[20:23], s46 offen sc1 lds
  s_add_u32 s46, s44, 9216
  s_add_u32 m0, s45, 32768
  s_nop 0
  buffer_load_dwordx4 v3, s[20:23], s46 offen sc1 lds
  s_add_u32 s46, s44, 10240
  s_add_u32 m0, s45, 36864
  s_nop 0
  buffer_load_dwordx4 v3, s[20:23], s46 offen sc1 lds
  s_add_u32 s46, s44, 11264
  s_add_u32 m0, s45, 53248
  s_nop 0
  buffer_load_dwordx4 v3, s[20:23], s46 offen sc1 lds
  s_add_u32 s46, s44, 12288
  s_add_u32 m0, s45, 57344
  s_nop 0
  buffer_load_dwordx4 v3, s[20:23], s46 offen sc1 lds
  s_add_u32 s46, s44, 13312
  s_add_u32 m0, s45, 73728
  s_nop 0
  buffer_load_dwordx4 v3, s[20:23], s46 offen sc1 lds
  s_add_u32 s46, s44, 14336
  s_add_u32 m0, s45, 77824
  s_nop 0
  buffer_load_dwordx4 v3, s[20:23], s46 offen sc1 lds
  s_add_u32 s46, s44, 15360
  s_add_u32 m0, s45, 94208
  s_nop 0
  buffer_load_dwordx4 v3, s[20:23], s46 offen sc1 lds
  s_waitcnt lgkmcnt(0)
  v_readfirstlane_b32 s47, v4
  s_nop 0
  s_cmp_eq_u32 s47, 1
  s_cbranch_scc1 sequential_preLN__softmax_full_mha__glu_gated_reglu__prompt_kernel_woe77
  s_add_u32 s46, s44, 0
  s_add_u32 m0, s45, 132096
  s_nop 0
  buffer_load_dwordx4 v3, s[20:23], s46 offen sc1 lds
  s_add_u32 s46, s44, 1024
  s_add_u32 m0, s45, 136192
  s_nop 0
  buffer_load_dwordx4 v3, s[20:23], s46 offen sc1 lds
  s_add_u32 s46, s44, 2048
  s_add_u32 m0, s45, 140288
  s_nop 0
  buffer_load_dwordx4 v3, s[20:23], s46 offen sc1 lds
  s_add_u32 s46, s44, 3072
  s_add_u32 m0, s45, 144384
  s_nop 0
  buffer_load_dwordx4 v3, s[20:23], s46 offen sc1 lds
  s_add_u32 s46, s44, 4096
  s_add_u32 m0, s45, 148480
  s_nop 0
  buffer_load_dwordx4 v3, s[20:23], s46 offen sc1 lds
  s_add_u32 s46, s44, 5120
  s_add_u32 m0, s45, 152576
  s_nop 0
  buffer_load_dwordx4 v3, s[20:23], s46 offen sc1 lds
  s_add_u32 s46, s44, 6144
  s_add_u32 m0, s45, 156672
  s_nop 0
  buffer_load_dwordx4 v3, s[20:23], s46 offen sc1 lds
  s_and_b32 s45, s45, 1024
  s_add_u32 s46, s45, 25755648
  s_add_u32 m0, s45, 160768
  s_nop 0
  buffer_load_dwordx4 v3, s[20:23], s46 offen sc1 lds
sequential_preLN__softmax_full_mha__glu_gated_reglu__prompt_kernel_woe77:
  s_waitcnt vmcnt(0)
  s_barrier
  s_sub_u32 s45, s26, 4
  s_lshr_b32 s44, s25, 2
  s_lshl_b32 s44, s44, 1
  s_and_b32 s46, s45, 1
  s_add_u32 s44, s44, s46
  s_mul_i32 s44, s44, 86
  s_lshr_b32 s46, s45, 1
  s_mul_i32 s46, s46, 43
  s_add_u32 s44, s44, s46
  s_lshl_b32 s44, s44, 10
  s_add_u32 s44, s44, 23068672
  s_lshl_b32 s45, s45, 10
  s_lshl_b32 s27, s24, 1
  s_cmp_ge_u32 s25, 15
  s_cselect_b32 s28, 1, 0
  s_add_u32 s27, s27, s28
  s_mul_i32 s28, s28, 15
  s_sub_u32 s28, s25, s28
  s_min_u32 s28, s28, 15
  s_cmp_eq_u32 s28, 15
  s_cbranch_scc1 sequential_preLN__softmax_full_mha__glu_gated_reglu__prompt_kernel_p4lskip78
  s_sub_u32 s29, s26, 4
  s_lshl_b32 s30, s27, 2
  s_add_u32 s30, s30, s29
  s_lshl_b32 s31, s30, 15
  s_add_u32 s31, s31, 10485760
  s_mul_i32 s33, s28, 196608
  s_and_b32 s34, s29, 1
  s_lshl_b32 s34, s34, 10
  s_add_u32 s33, s33, s34
  s_lshr_b32 s35, s29, 1
  s_mul_i32 s37, s35, 98304
  s_add_u32 s33, s33, s37
  s_mul_i32 s35, s35, 6144
  s_add_u32 s34, s34, s35
  s_lshl_b32 s36, s29, 11
  s_cmp_eq_u32 s28, 14
  s_cselect_b32 s39, 0x40000000, 0
  s_lshr_b32 s38, s29, 1
  s_mul_i32 s38, s38, s39
  s_add_u32 s33, s33, s38
  s_sub_u32 s39, s39, s38
  s_add_u32 s39, s39, s33
  s_mov_b32 s40, 0
  s_and_b32 s40, s40, 15
  s_lshl_b32 s40, s40, 11
  s_add_u32 s35, s33, s40
  s_add_u32 s35, s35, 19922944
  s_add_u32 m0, s34, 0
  s_nop 0
  buffer_load_dwordx4 v3, s[20:23], s35 offen sc1 lds
  s_add_u32 s35, s33, s40
  s_add_u32 s35, s35, 19955712
  s_add_u32 m0, s34, 2048
  s_nop 0
  buffer_load_dwordx4 v3, s[20:23], s35 offen sc1 lds
  s_add_u32 s35, s39, s40
  s_add_u32 s35, s35, 19988480
  s_add_u32 m0, s34, 4096
  s_nop 0
  buffer_load_dwordx4 v3, s[20:23], s35 offen sc1 lds
  s_mov_b32 s40, 1
  s_and_b32 s40, s40, 15
  s_lshl_b32 s40, s40, 11
  s_add_u32 s35, s33, s40
  s_add_u32 s35, s35, 19922944
  s_add_u32 m0, s34, 20480
  s_nop 0
  buffer_load_dwordx4 v3, s[20:23], s35 offen sc1 lds
  s_add_u32 s35, s33, s40
  s_add_u32 s35, s35, 19955712
  s_add_u32 m0, s34, 22528
  s_nop 0
  buffer_load_dwordx4 v3, s[20:23], s35 offen sc1 lds
  s_add_u32 s35, s39, s40
  s_add_u32 s35, s35, 19988480
  s_add_u32 m0, s34, 24576
  s_nop 0
  buffer_load_dwordx4 v3, s[20:23], s35 offen sc1 lds
  s_mov_b32 s40, 2
  s_and_b32 s40, s40, 15
  s_lshl_b32 s40, s40, 11
  s_add_u32 s35, s33, s40
  s_add_u32 s35, s35, 19922944
  s_add_u32 m0, s34, 40960
  s_nop 0
  buffer_load_dwordx4 v3, s[20:23], s35 offen sc1 lds
  s_add_u32 s35, s33, s40
  s_add_u32 s35, s35, 19955712
  s_add_u32 m0, s34, 43008
  s_nop 0
  buffer_load_dwordx4 v3, s[20:23], s35 offen sc1 lds
  s_add_u32 s35, s39, s40
  s_add_u32 s35, s35, 19988480
  s_add_u32 m0, s34, 45056
  s_nop 0
  buffer_load_dwordx4 v3, s[20:23], s35 offen sc1 lds
  s_mov_b32 s40, 3
  s_and_b32 s40, s40, 15
  s_lshl_b32 s40, s40, 11
  s_add_u32 s35, s33, s40
  s_add_u32 s35, s35, 19922944
  s_add_u32 m0, s34, 61440
  s_nop 0
  buffer_load_dwordx4 v3, s[20:23], s35 offen sc1 lds
  s_add_u32 s35, s33, s40
  s_add_u32 s35, s35, 19955712
  s_add_u32 m0, s34, 63488
  s_nop 0
  buffer_load_dwordx4 v3, s[20:23], s35 offen sc1 lds
  s_add_u32 s35, s39, s40
  s_add_u32 s35, s35, 19988480
  s_add_u32 m0, s34, 65536
  s_nop 0
  buffer_load_dwordx4 v3, s[20:23], s35 offen sc1 lds
  s_mov_b32 s40, 4
  s_and_b32 s40, s40, 15
  s_lshl_b32 s40, s40, 11
  s_add_u32 s35, s33, s40
  s_add_u32 s35, s35, 19922944
  s_add_u32 m0, s34, 81920
  s_nop 0
  buffer_load_dwordx4 v3, s[20:23], s35 offen sc1 lds
  s_add_u32 s35, s33, s40
  s_add_u32 s35, s35, 19955712
  s_add_u32 m0, s34, 83968
  s_nop 0
  buffer_load_dwordx4 v3, s[20:23], s35 offen sc1 lds
  s_add_u32 s35, s39, s40
  s_add_u32 s35, s35, 19988480
  s_add_u32 m0, s34, 86016
  s_nop 0
  buffer_load_dwordx4 v3, s[20:23], s35 offen sc1 lds
  s_barrier
  s_barrier
  s_mov_b32 s40, 5
  s_and_b32 s40, s40, 15
  s_lshl_b32 s40, s40, 11
  s_add_u32 s35, s33, s40
  s_add_u32 s35, s35, 19922944
  s_add_u32 m0, s34, 102400
  s_nop 0
  buffer_load_dwordx4 v3, s[20:23], s35 offen sc1 lds
  s_add_u32 s35, s33, s40
  s_add_u32 s35, s35, 19955712
  s_add_u32 m0, s34, 104448
  s_nop 0
  buffer_load_dwordx4 v3, s[20:23], s35 offen sc1 lds
  s_add_u32 s35, s39, s40
  s_add_u32 s35, s35, 19988480
  s_add_u32 m0, s34, 106496
  s_nop 0
  buffer_load_dwordx4 v3, s[20:23], s35 offen sc1 lds
  s_mov_b32 s40, 6
  s_and_b32 s40, s40, 15
  s_lshl_b32 s40, s40, 11
  s_add_u32 s35, s33, s40
  s_add_u32 s35, s35, 19922944
  s_add_u32 m0, s34, 122880
  s_nop 0
  buffer_load_dwordx4 v3, s[20:23], s35 offen sc1 lds
  s_add_u32 s35, s33, s40
  s_add_u32 s35, s35, 19955712
  s_add_u32 m0, s34, 124928
  s_nop 0
  buffer_load_dwordx4 v3, s[20:23], s35 offen sc1 lds
  s_add_u32 s35, s39, s40
  s_add_u32 s35, s35, 19988480
  s_add_u32 m0, s34, 126976
  s_nop 0
  buffer_load_dwordx4 v3, s[20:23], s35 offen sc1 lds
  s_mov_b32 s40, 7
  s_and_b32 s40, s40, 15
  s_lshl_b32 s40, s40, 11
  s_add_u32 s35, s33, s40
  s_add_u32 s35, s35, 19922944
  s_add_u32 m0, s34, 143360
  s_nop 0
  buffer_load_dwordx4 v3, s[20:23], s35 offen sc1 lds
  s_add_u32 s35, s33, s40
  s_add_u32 s35, s35, 19955712
  s_add_u32 m0, s34, 145408
  s_nop 0
  buffer_load_dwordx4 v3, s[20:23], s35 offen sc1 lds
  s_add_u32 s35, s39, s40
  s_add_u32 s35, s35, 19988480
  s_add_u32 m0, s34, 147456
  s_nop 0
  buffer_load_dwordx4 v3, s[20:23], s35 offen sc1 lds
  s_barrier
  s_mov_b32 s40, 1
  s_and_b32 s40, s40, 15
  s_lshl_b32 s40, s40, 11
  s_add_u32 s35, s31, s40
  s_add_u32 m0, s36, 32768
  s_nop 0
  buffer_load_dwordx4 v3, s[20:23], s35 offen sc1 lds
  buffer_load_dwordx4 v3, s[20:23], s35 offen offset:1024 sc1 lds
  s_mov_b32 s40, 2
  s_and_b32 s40, s40, 15
  s_lshl_b32 s40, s40, 11
  s_add_u32 s35, s31, s40
  s_add_u32 m0, s36, 53248
  s_nop 0
  buffer_load_dwordx4 v3, s[20:23], s35 offen sc1 lds
  buffer_load_dwordx4 v3, s[20:23], s35 offen offset:1024 sc1 lds
  s_mov_b32 s40, 3
  s_and_b32 s40, s40, 15
  s_lshl_b32 s40, s40, 11
  s_add_u32 s35, s31, s40
  s_add_u32 m0, s36, 73728
  s_nop 0
  buffer_load_dwordx4 v3, s[20:23], s35 offen sc1 lds
  buffer_load_dwordx4 v3, s[20:23], s35 offen offset:1024 sc1 lds
  s_waitcnt vmcnt(27)
  s_barrier
  s_mov_b32 s40, 4
  s_and_b32 s40, s40, 15
  s_lshl_b32 s40, s40, 11
  s_add_u32 s35, s31, s40
  s_add_u32 m0, s36, 94208
  s_nop 0
  buffer_load_dwordx4 v3, s[20:23], s35 offen sc1 lds
  buffer_load_dwordx4 v3, s[20:23], s35 offen offset:1024 sc1 lds
  s_mov_b32 s40, 5
  s_and_b32 s40, s40, 15
  s_lshl_b32 s40, s40, 11
  s_add_u32 s35, s31, s40
  s_add_u32 m0, s36, 114688
  s_nop 0
  buffer_load_dwordx4 v3, s[20:23], s35 offen sc1 lds
  buffer_load_dwordx4 v3, s[20:23], s35 offen offset:1024 sc1 lds
  s_waitcnt vmcnt(8)
  s_barrier
  s_mov_b32 s40, 6
  s_and_b32 s40, s40, 15
  s_lshl_b32 s40, s40, 11
  s_add_u32 s35, s31, s40
  s_add_u32 m0, s36, 135168
  s_nop 0
  buffer_load_dwordx4 v3, s[20:23], s35 offen sc1 lds
  buffer_load_dwordx4 v3, s[20:23], s35 offen offset:1024 sc1 lds
  s_waitcnt vmcnt(8)
  s_barrier
  s_mov_b32 s40, 7
  s_and_b32 s40, s40, 15
  s_lshl_b32 s40, s40, 11
  s_add_u32 s35, s31, s40
  s_add_u32 m0, s36, 155648
  s_nop 0
  buffer_load_dwordx4 v3, s[20:23], s35 offen sc1 lds
  buffer_load_dwordx4 v3, s[20:23], s35 offen offset:1024 sc1 lds
  s_mov_b32 s40, 8
  s_and_b32 s40, s40, 15
  s_lshl_b32 s40, s40, 11
  s_add_u32 s35, s33, s40
  s_add_u32 s35, s35, 19922944
  s_add_u32 m0, s34, 0
  s_nop 0
  buffer_load_dwordx4 v3, s[20:23], s35 offen sc1 lds
  s_add_u32 s35, s33, s40
  s_add_u32 s35, s35, 19955712
  s_add_u32 m0, s34, 2048
  s_nop 0
  buffer_load_dwordx4 v3, s[20:23], s35 offen sc1 lds
  s_add_u32 s35, s39, s40
  s_add_u32 s35, s35, 19988480
  s_add_u32 m0, s34, 4096
  s_nop 0
  buffer_load_dwordx4 v3, s[20:23], s35 offen sc1 lds
  s_waitcnt vmcnt(11)
  s_barrier
  s_mov_b32 s40, 8
  s_and_b32 s40, s40, 15
  s_lshl_b32 s40, s40, 11
  s_add_u32 s35, s31, s40
  s_add_u32 m0, s36, 12288
  s_nop 0
  buffer_load_dwordx4 v3, s[20:23], s35 offen sc1 lds
  buffer_load_dwordx4 v3, s[20:23], s35 offen offset:1024 sc1 lds
  s_mov_b32 s40, 9
  s_and_b32 s40, s40, 15
  s_lshl_b32 s40, s40, 11
  s_add_u32 s35, s33, s40
  s_add_u32 s35, s35, 19922944
  s_add_u32 m0, s34, 20480
  s_nop 0
  buffer_load_dwordx4 v3, s[20:23], s35 offen sc1 lds
  s_add_u32 s35, s33, s40
  s_add_u32 s35, s35, 19955712
  s_add_u32 m0, s34, 22528
  s_nop 0
  buffer_load_dwordx4 v3, s[20:23], s35 offen sc1 lds
  s_add_u32 s35, s39, s40
  s_add_u32 s35, s35, 19988480
  s_add_u32 m0, s34, 24576
  s_nop 0
  buffer_load_dwordx4 v3, s[20:23], s35 offen sc1 lds
  s_waitcnt vmcnt(14)
  s_barrier
  s_mov_b32 s40, 9
  s_and_b32 s40, s40, 15
  s_lshl_b32 s40, s40, 11
  s_add_u32 s35, s31, s40
  s_add_u32 m0, s36, 32768
  s_nop 0
  buffer_load_dwordx4 v3, s[20:23], s35 offen sc1 lds
  buffer_load_dwordx4 v3, s[20:23], s35 offen offset:1024 sc1 lds
  s_mov_b32 s40, 10
  s_and_b32 s40, s40, 15
  s_lshl_b32 s40, s40, 11
  s_add_u32 s35, s33, s40
  s_add_u32 s35, s35, 19922944
  s_add_u32 m0, s34, 40960
  s_nop 0
  buffer_load_dwordx4 v3, s[20:23], s35 offen sc1 lds
  s_add_u32 s35, s33, s40
  s_add_u32 s35, s35, 19955712
  s_add_u32 m0, s34, 43008
  s_nop 0
  buffer_load_dwordx4 v3, s[20:23], s35 offen sc1 lds
  s_add_u32 s35, s39, s40
  s_add_u32 s35, s35, 19988480
  s_add_u32 m0, s34, 45056
  s_nop 0
  buffer_load_dwordx4 v3, s[20:23], s35 offen sc1 lds
  s_waitcnt vmcnt(17)
  s_barrier
  s_mov_b32 s40, 10
  s_and_b32 s40, s40, 15
  s_lshl_b32 s40, s40, 11
  s_add_u32 s35, s31, s40
  s_add_u32 m0, s36, 53248
  s_nop 0
  buffer_load_dwordx4 v3, s[20:23], s35 offen sc1 lds
  buffer_load_dwordx4 v3, s[20:23], s35 offen offset:1024 sc1 lds
  s_mov_b32 s40, 11
  s_and_b32 s40, s40, 15
  s_lshl_b32 s40, s40, 11
  s_add_u32 s35, s33, s40
  s_add_u32 s35, s35, 19922944
  s_add_u32 m0, s34, 61440
  s_nop 0
  buffer_load_dwordx4 v3, s[20:23], s35 offen sc1 lds
  s_add_u32 s35, s33, s40
  s_add_u32 s35, s35, 19955712
  s_add_u32 m0, s34, 63488
  s_nop 0
  buffer_load_dwordx4 v3, s[20:23], s35 offen sc1 lds
  s_add_u32 s35, s39, s40
  s_add_u32 s35, s35, 19988480
  s_add_u32 m0, s34, 65536
  s_nop 0
  buffer_load_dwordx4 v3, s[20:23], s35 offen sc1 lds
  s_waitcnt vmcnt(20)
  s_barrier
  s_mov_b32 s40, 11
  s_and_b32 s40, s40, 15
  s_lshl_b32 s40, s40, 11
  s_add_u32 s35, s31, s40
  s_add_u32 m0, s36, 73728
  s_nop 0
  buffer_load_dwordx4 v3, s[20:23], s35 offen sc1 lds
  buffer_load_dwordx4 v3, s[20:23], s35 offen offset:1024 sc1 lds
  s_mov_b32 s40, 12
  s_and_b32 s40, s40, 15
  s_lshl_b32 s40, s40, 11
  s_add_u32 s35, s33, s40
  s_add_u32 s35, s35, 19922944
  s_add_u32 m0, s34, 81920
  s_nop 0
  buffer_load_dwordx4 v3, s[20:23], s35 offen sc1 lds
  s_add_u32 s35, s33, s40
  s_add_u32 s35, s35, 19955712
  s_add_u32 m0, s34, 83968
  s_nop 0
  buffer_load_dwordx4 v3, s[20:23], s35 offen sc1 lds
  s_add_u32 s35, s39, s40
  s_add_u32 s35, s35, 19988480
  s_add_u32 m0, s34, 86016
  s_nop 0
  buffer_load_dwordx4 v3, s[20:23], s35 offen sc1 lds
  s_waitcnt vmcnt(23)
  s_barrier
  s_mov_b32 s40, 12
  s_and_b32 s40, s40, 15
  s_lshl_b32 s40, s40, 11
  s_add_u32 s35, s31, s40
  s_add_u32 m0, s36, 94208
  s_nop 0
  buffer_load_dwordx4 v3, s[20:23], s35 offen sc1 lds
  buffer_load_dwordx4 v3, s[20:23], s35 offen offset:1024 sc1 lds
  s_mov_b32 s40, 13
  s_and_b32 s40, s40, 15
  s_lshl_b32 s40, s40, 11
  s_add_u32 s35, s33, s40
  s_add_u32 s35, s35, 19922944
  s_add_u32 m0, s34, 102400
  s_nop 0
  buffer_load_dwordx4 v3, s[20:23], s35 offen sc1 lds
  s_add_u32 s35, s33, s40
  s_add_u32 s35, s35, 19955712
  s_add_u32 m0, s34, 104448
  s_nop 0
  buffer_load_dwordx4 v3, s[20:23], s35 offen sc1 lds
  s_add_u32 s35, s39, s40
  s_add_u32 s35, s35, 19988480
  s_add_u32 m0, s34, 106496
  s_nop 0
  buffer_load_dwordx4 v3, s[20:23], s35 offen sc1 lds
  s_waitcnt vmcnt(23)
  s_barrier
  s_mov_b32 s40, 13
  s_and_b32 s40, s40, 15
  s_lshl_b32 s40, s40, 11
  s_add_u32 s35, s31, s40
  s_add_u32 m0, s36, 114688
  s_nop 0
  buffer_load_dwordx4 v3, s[20:23], s35 offen sc1 lds
  buffer_load_dwordx4 v3, s[20:23], s35 offen offset:1024 sc1 lds
  s_mov_b32 s40, 14
  s_and_b32 s40, s40, 15
  s_lshl_b32 s40, s40, 11
  s_add_u32 s35, s33, s40
  s_add_u32 s35, s35, 19922944
  s_add_u32 m0, s34, 122880
  s_nop 0
  buffer_load_dwordx4 v3, s[20:23], s35 offen sc1 lds
  s_add_u32 s35, s33, s40
  s_add_u32 s35, s35, 19955712
  s_add_u32 m0, s34, 124928
  s_nop 0
  buffer_load_dwordx4 v3, s[20:23], s35 offen sc1 lds
  s_add_u32 s35, s39, s40
  s_add_u32 s35, s35, 19988480
  s_add_u32 m0, s34, 126976
  s_nop 0
  buffer_load_dwordx4 v3, s[20:23], s35 offen sc1 lds
  s_waitcnt vmcnt(23)
  s_barrier
  s_mov_b32 s40, 14
  s_and_b32 s40, s40, 15
  s_lshl_b32 s40, s40, 11
  s_add_u32 s35, s31, s40
  s_add_u32 m0, s36, 135168
  s_nop 0
  buffer_load_dwordx4 v3, s[20:23], s35 offen sc1 lds
  buffer_load_dwordx4 v3, s[20:23], s35 offen offset:1024 sc1 lds
  s_mov_b32 s40, 15
  s_and_b32 s40, s40, 15
  s_lshl_b32 s40, s40, 11
  s_add_u32 s35, s33, s40
  s_add_u32 s35, s35, 19922944
  s_add_u32 m0, s34, 143360
  s_nop 0
  buffer_load_dwordx4 v3, s[20:23], s35 offen sc1 lds
  s_add_u32 s35, s33, s40
  s_add_u32 s35, s35, 19955712
  s_add_u32 m0, s34, 145408
  s_nop 0
  buffer_load_dwordx4 v3, s[20:23], s35 offen sc1 lds
  s_add_u32 s35, s39, s40
  s_add_u32 s35, s35, 19988480
  s_add_u32 m0, s34, 147456
  s_nop 0
  buffer_load_dwordx4 v3, s[20:23], s35 offen sc1 lds
  s_waitcnt vmcnt(23)
  s_barrier
  s_mov_b32 s40, 15
  s_and_b32 s40, s40, 15
  s_lshl_b32 s40, s40, 11
  s_add_u32 s35, s31, s40
  s_add_u32 m0, s36, 155648
  s_nop 0
  buffer_load_dwordx4 v3, s[20:23], s35 offen sc1 lds
  buffer_load_dwordx4 v3, s[20:23], s35 offen offset:1024 sc1 lds
  s_add_u32 s46, s44, 0
  s_add_u32 m0, s45, 0
  s_nop 0
  buffer_load_dwordx4 v3, s[20:23], s46 offen sc1 lds
  s_add_u32 s46, s44, 1024
  s_add_u32 m0, s45, 4096
  s_nop 0
  buffer_load_dwordx4 v3, s[20:23], s46 offen sc1 lds
  s_add_u32 s46, s44, 2048
  s_add_u32 m0, s45, 8192
  s_nop 0
  buffer_load_dwordx4 v3, s[20:23], s46 offen sc1 lds
  s_add_u32 s46, s44, 3072
  s_add_u32 m0, s45, 12288
  s_nop 0
  buffer_load_dwordx4 v3, s[20:23], s46 offen sc1 lds
  s_add_u32 s46, s44, 4096
  s_add_u32 m0, s45, 16384
  s_nop 0
  buffer_load_dwordx4 v3, s[20:23], s46 offen sc1 lds
  s_waitcnt vmcnt(25)
  s_barrier
  s_add_u32 s46, s44, 5120
  s_add_u32 m0, s45, 20480
  s_nop 0
  buffer_load_dwordx4 v3, s[20:23], s46 offen sc1 lds
  s_add_u32 s46, s44, 6144
  s_add_u32 m0, s45, 24576
  s_nop 0
  buffer_load_dwordx4 v3, s[20:23], s46 offen sc1 lds
  s_add_u32 s46, s44, 7168
  s_add_u32 m0, s45, 28672
  s_nop 0
  buffer_load_dwordx4 v3, s[20:23], s46 offen sc1 lds
  s_add_u32 s46, s44, 8192
  s_add_u32 m0, s45, 32768
  s_nop 0
  buffer_load_dwordx4 v3, s[20:23], s46 offen sc1 lds
  s_add_u32 s46, s44, 9216
  s_add_u32 m0, s45, 36864
  s_nop 0
  buffer_load_dwordx4 v3, s[20:23], s46 offen sc1 lds
  s_waitcnt vmcnt(25)
  s_barrier
  s_add_u32 s46, s44, 10240
  s_add_u32 m0, s45, 40960
  s_nop 0
  buffer_load_dwordx4 v3, s[20:23], s46 offen sc1 lds
  s_add_u32 s46, s44, 11264
  s_add_u32 m0, s45, 45056
  s_nop 0
  buffer_load_dwordx4 v3, s[20:23], s46 offen sc1 lds
  s_add_u32 s46, s44, 12288
  s_add_u32 m0, s45, 49152
  s_nop 0
  buffer_load_dwordx4 v3, s[20:23], s46 offen sc1 lds
  s_add_u32 s46, s44, 13312
  s_add_u32 m0, s45, 53248
  s_nop 0
  buffer_load_dwordx4 v3, s[20:23], s46 offen sc1 lds
  s_add_u32 s46, s44, 14336
  s_add_u32 m0, s45, 57344
  s_nop 0
  buffer_load_dwordx4 v3, s[20:23], s46 offen sc1 lds
  s_waitcnt vmcnt(25)
  s_barrier
  s_add_u32 s46, s44, 15360
  s_add_u32 m0, s45, 61440
  s_nop 0
  buffer_load_dwordx4 v3, s[20:23], s46 offen sc1 lds
  s_add_u32 s46, s44, 16384
  s_add_u32 m0, s45, 65536
  s_nop 0
  buffer_load_dwordx4 v3, s[20:23], s46 offen sc1 lds
  s_add_u32 s46, s44, 17408
  s_add_u32 m0, s45, 69632
  s_nop 0
  buffer_load_dwordx4 v3, s[20:23], s46 offen sc1 lds
  s_add_u32 s46, s44, 18432
  s_add_u32 m0, s45, 73728
  s_nop 0
  buffer_load_dwordx4 v3, s[20:23], s46 offen sc1 lds
  s_add_u32 s46, s44, 19456
  s_add_u32 m0, s45, 77824
  s_nop 0
  buffer_load_dwordx4 v3, s[20:23], s46 offen sc1 lds
  s_waitcnt vmcnt(25)
  s_barrier
  s_add_u32 s46, s44, 20480
  s_add_u32 m0, s45, 81920
  s_nop 0
  buffer_load_dwordx4 v3, s[20:23], s46 offen sc1 lds
  s_add_u32 s46, s44, 21504
  s_add_u32 m0, s45, 86016
  s_nop 0
  buffer_load_dwordx4 v3, s[20:23], s46 offen sc1 lds
  s_add_u32 s46, s44, 22528
  s_add_u32 m0, s45, 90112
  s_nop 0
  buffer_load_dwordx4 v3, s[20:23], s46 offen sc1 lds
  s_add_u32 s46, s44, 23552
  s_add_u32 m0, s45, 94208
  s_nop 0
  buffer_load_dwordx4 v3, s[20:23], s46 offen sc1 lds
  s_add_u32 s46, s44, 24576
  s_add_u32 m0, s45, 98304
  s_nop 0
  buffer_load_dwordx4 v3, s[20:23], s46 offen sc1 lds
  s_waitcnt vmcnt(25)
  s_barrier
  s_add_u32 s46, s44, 25600
  s_add_u32 m0, s45, 102400
  s_nop 0
  buffer_load_dwordx4 v3, s[20:23], s46 offen sc1 lds
  s_add_u32 s46, s44, 26624
  s_add_u32 m0, s45, 106496
  s_nop 0
  buffer_load_dwordx4 v3, s[20:23], s46 offen sc1 lds
  s_add_u32 s46, s44, 27648
  s_add_u32 m0, s45, 110592
  s_nop 0
  buffer_load_dwordx4 v3, s[20:23], s46 offen sc1 lds
  s_add_u32 s46, s44, 28672
  s_add_u32 m0, s45, 114688
  s_nop 0
  buffer_load_dwordx4 v3, s[20:23], s46 offen sc1 lds
  s_add_u32 s46, s44, 29696
  s_add_u32 m0, s45, 118784
  s_nop 0
  buffer_load_dwordx4 v3, s[20:23], s46 offen sc1 lds
  s_barrier
  s_add_u32 s46, s44, 30720
  s_add_u32 m0, s45, 122880
  s_nop 0
  buffer_load_dwordx4 v3, s[20:23], s46 offen sc1 lds
  s_add_u32 s46, s44, 31744
  s_add_u32 m0, s45, 126976
  s_nop 0
  buffer_load_dwordx4 v3, s[20:23], s46 offen sc1 lds
  s_add_u32 s46, s44, 32768
  s_add_u32 m0, s45, 131072
  s_nop 0
  buffer_load_dwordx4 v3, s[20:23], s46 offen sc1 lds
  s_add_u32 s46, s44, 33792
  s_add_u32 m0, s45, 135168
  s_nop 0
  buffer_load_dwordx4 v3, s[20:23], s46 offen sc1 lds
  s_add_u32 s46, s44, 34816
  s_add_u32 m0, s45, 139264
  s_nop 0
  buffer_load_dwordx4 v3, s[20:23], s46 offen sc1 lds
  s_barrier
  s_branch sequential_preLN__softmax_full_mha__glu_gated_reglu__prompt_kernel_p4ljoin79
sequential_preLN__softmax_full_mha__glu_gated_reglu__prompt_kernel_p4lskip78:
  s_barrier
  s_barrier
  s_barrier
  s_add_u32 s46, s44, 0
  s_add_u32 m0, s45, 0
  s_nop 0
  buffer_load_dwordx4 v3, s[20:23], s46 offen sc1 lds
  s_add_u32 s46, s44, 1024
  s_add_u32 m0, s45, 4096
  s_nop 0
  buffer_load_dwordx4 v3, s[20:23], s46 offen sc1 lds
  s_add_u32 s46, s44, 2048
  s_add_u32 m0, s45, 8192
  s_nop 0
  buffer_load_dwordx4 v3, s[20:23], s46 offen sc1 lds
  s_add_u32 s46, s44, 3072
  s_add_u32 m0, s45, 12288
  s_nop 0
  buffer_load_dwordx4 v3, s[20:23], s46 offen sc1 lds
  s_add_u32 s46, s44, 4096
  s_add_u32 m0, s45, 16384
  s_nop 0
  buffer_load_dwordx4 v3, s[20:23], s46 offen sc1 lds
  s_add_u32 s46, s44, 5120
  s_add_u32 m0, s45, 20480
  s_nop 0
  buffer_load_dwordx4 v3, s[20:23], s46 offen sc1 lds
  s_add_u32 s46, s44, 6144
  s_add_u32 m0, s45, 24576
  s_nop 0
  buffer_load_dwordx4 v3, s[20:23], s46 offen sc1 lds
  s_add_u32 s46, s44, 7168
  s_add_u32 m0, s45, 28672
  s_nop 0
  buffer_load_dwordx4 v3, s[20:23], s46 offen sc1 lds
  s_add_u32 s46, s44, 8192
  s_add_u32 m0, s45, 32768
  s_nop 0
  buffer_load_dwordx4 v3, s[20:23], s46 offen sc1 lds
  s_add_u32 s46, s44, 9216
  s_add_u32 m0, s45, 36864
  s_nop 0
  buffer_load_dwordx4 v3, s[20:23], s46 offen sc1 lds
  s_add_u32 s46, s44, 10240
  s_add_u32 m0, s45, 40960
  s_nop 0
  buffer_load_dwordx4 v3, s[20:23], s46 offen sc1 lds
  s_add_u32 s46, s44, 11264
  s_add_u32 m0, s45, 45056
  s_nop 0
  buffer_load_dwordx4 v3, s[20:23], s46 offen sc1 lds
  s_add_u32 s46, s44, 12288
  s_add_u32 m0, s45, 49152
  s_nop 0
  buffer_load_dwordx4 v3, s[20:23], s46 offen sc1 lds
  s_add_u32 s46, s44, 13312
  s_add_u32 m0, s45, 53248
  s_nop 0
  buffer_load_dwordx4 v3, s[20:23], s46 offen sc1 lds
  s_add_u32 s46, s44, 14336
  s_add_u32 m0, s45, 57344
  s_nop 0
  buffer_load_dwordx4 v3, s[20:23], s46 offen sc1 lds
  s_add_u32 s46, s44, 15360
  s_add_u32 m0, s45, 61440
  s_nop 0
  buffer_load_dwordx4 v3, s[20:23], s46 offen sc1 lds
  s_add_u32 s46, s44, 16384
  s_add_u32 m0, s45, 65536
  s_nop 0
  buffer_load_dwordx4 v3, s[20:23], s46 offen sc1 lds
  s_add_u32 s46, s44, 17408
  s_add_u32 m0, s45, 69632
  s_nop 0
  buffer_load_dwordx4 v3, s[20:23], s46 offen sc1 lds
  s_add_u32 s46, s44, 18432
  s_add_u32 m0, s45, 73728
  s_nop 0
  buffer_load_dwordx4 v3, s[20:23], s46 offen sc1 lds
  s_add_u32 s46, s44, 19456
  s_add_u32 m0, s45, 77824
  s_nop 0
  buffer_load_dwordx4 v3, s[20:23], s46 offen sc1 lds
  s_add_u32 s46, s44, 20480
  s_add_u32 m0, s45, 81920
  s_nop 0
  buffer_load_dwordx4 v3, s[20:23], s46 offen sc1 lds
  s_add_u32 s46, s44, 21504
  s_add_u32 m0, s45, 86016
  s_nop 0
  buffer_load_dwordx4 v3, s[20:23], s46 offen sc1 lds
  s_add_u32 s46, s44, 22528
  s_add_u32 m0, s45, 90112
  s_nop 0
  buffer_load_dwordx4 v3, s[20:23], s46 offen sc1 lds
  s_add_u32 s46, s44, 23552
  s_add_u32 m0, s45, 94208
  s_nop 0
  buffer_load_dwordx4 v3, s[20:23], s46 offen sc1 lds
  s_add_u32 s46, s44, 24576
  s_add_u32 m0, s45, 98304
  s_nop 0
  buffer_load_dwordx4 v3, s[20:23], s46 offen sc1 lds
  s_add_u32 s46, s44, 25600
  s_add_u32 m0, s45, 102400
  s_nop 0
  buffer_load_dwordx4 v3, s[20:23], s46 offen sc1 lds
  s_add_u32 s46, s44, 26624
  s_add_u32 m0, s45, 106496
  s_nop 0
  buffer_load_dwordx4 v3, s[20:23], s46 offen sc1 lds
  s_add_u32 s46, s44, 27648
  s_add_u32 m0, s45, 110592
  s_nop 0
  buffer_load_dwordx4 v3, s[20:23], s46 offen sc1 lds
  s_add_u32 s46, s44, 28672
  s_add_u32 m0, s45, 114688
  s_nop 0
  buffer_load_dwordx4 v3, s[20:23], s46 offen sc1 lds
  s_add_u32 s46, s44, 29696
  s_add_u32 m0, s45, 118784
  s_nop 0
  buffer_load_dwordx4 v3, s[20:23], s46 offen sc1 lds
  s_add_u32 s46, s44, 30720
  s_add_u32 m0, s45, 122880
  s_nop 0
  buffer_load_dwordx4 v3, s[20:23], s46 offen sc1 lds
  s_add_u32 s46, s44, 31744
  s_add_u32 m0, s45, 126976
  s_nop 0
  buffer_load_dwordx4 v3, s[20:23], s46 offen sc1 lds
  s_add_u32 s46, s44, 32768
  s_add_u32 m0, s45, 131072
  s_nop 0
  buffer_load_dwordx4 v3, s[20:23], s46 offen sc1 lds
  s_add_u32 s46, s44, 33792
  s_add_u32 m0, s45, 135168
  s_nop 0
  buffer_load_dwordx4 v3, s[20:23], s46 offen sc1 lds
  s_add_u32 s46, s44, 34816
  s_add_u32 m0, s45, 139264
  s_nop 0
  buffer_load_dwordx4 v3, s[20:23], s46 offen sc1 lds
sequential_preLN__softmax_full_mha__glu_gated_reglu__prompt_kernel_p4ljoin79:
  s_add_u32 s46, s44, 35840
  s_add_u32 m0, s45, 143360
  s_nop 0
  buffer_load_dwordx4 v3, s[20:23], s46 offen sc1 lds
  s_add_u32 s46, s44, 36864
  s_add_u32 m0, s45, 147456
  s_nop 0
  buffer_load_dwordx4 v3, s[20:23], s46 offen sc1 lds
  s_add_u32 s46, s44, 37888
  s_add_u32 m0, s45, 151552
  s_nop 0
  buffer_load_dwordx4 v3, s[20:23], s46 offen sc1 lds
  s_add_u32 s46, s44, 38912
  s_add_u32 m0, s45, 155648
  s_nop 0
  buffer_load_dwordx4 v3, s[20:23], s46 offen sc1 lds
  s_waitcnt vmcnt(14)
  s_barrier
  s_waitcnt vmcnt(0)
  s_barrier
  s_endpgm
sequential_preLN__softmax_full_mha__glu_gated_reglu__prompt_kernel_H255:
  s_lshl_b32 s33, s62, 16
  s_mov_b32 s31, 0
  s_and_b32 s31, s31, 7
  s_lshl_b32 s31, s31, 13
  s_add_u32 s31, s31, s33
  s_add_u32 s34, s31, 2097152
  s_mov_b32 m0, 0
  s_nop 0
  buffer_load_dwordx4 v3, s[20:23], s34 offen sc1 lds
  buffer_load_dwordx4 v3, s[20:23], s34 offen offset:1024 sc1 lds
  buffer_load_dwordx4 v3, s[20:23], s34 offen offset:2048 sc1 lds
  buffer_load_dwordx4 v3, s[20:23], s34 offen offset:3072 sc1 lds
  s_add_u32 s34, s31, 2101248
  s_mov_b32 m0, 4096
  s_nop 0
  buffer_load_dwordx4 v3, s[20:23], s34 offen sc1 lds
  buffer_load_dwordx4 v3, s[20:23], s34 offen offset:1024 sc1 lds
  buffer_load_dwordx4 v3, s[20:23], s34 offen offset:2048 sc1 lds
  buffer_load_dwordx4 v3, s[20:23], s34 offen offset:3072 sc1 lds
  s_add_u32 s34, s31, 4194304
  s_mov_b32 m0, 65536
  s_nop 0
  buffer_load_dwordx4 v3, s[20:23], s34 offen sc1 lds
  buffer_load_dwordx4 v3, s[20:23], s34 offen offset:1024 sc1 lds
  buffer_load_dwordx4 v3, s[20:23], s34 offen offset:2048 sc1 lds
  buffer_load_dwordx4 v3, s[20:23], s34 offen offset:3072 sc1 lds
  s_add_u32 s34, s31, 4198400
  s_mov_b32 m0, 69632
  s_nop 0
  buffer_load_dwordx4 v3, s[20:23], s34 offen sc1 lds
  buffer_load_dwordx4 v3, s[20:23], s34 offen offset:1024 sc1 lds
  buffer_load_dwordx4 v3, s[20:23], s34 offen offset:2048 sc1 lds
  buffer_load_dwordx4 v3, s[20:23], s34 offen offset:3072 sc1 lds
  s_waitcnt lgkmcnt(0)
  s_barrier
  s_mov_b32 s31, 1
  s_and_b32 s31, s31, 7
  s_lshl_b32 s31, s31, 13
  s_add_u32 s31, s31, s33
  s_add_u32 s34, s31, 2097152
  s_mov_b32 m0, 8192
  s_nop 0
  buffer_load_dwordx4 v3, s[20:23], s34 offen sc1 lds
  buffer_load_dwordx4 v3, s[20:23], s34 offen offset:1024 sc1 lds
  buffer_load_dwordx4 v3, s[20:23], s34 offen offset:2048 sc1 lds
  buffer_load_dwordx4 v3, s[20:23], s34 offen offset:3072 sc1 lds
  s_add_u32 s34, s31, 2101248
  s_mov_b32 m0, 12288
  s_nop 0
  buffer_load_dwordx4 v3, s[20:23], s34 offen sc1 lds
  buffer_load_dwordx4 v3, s[20:23], s34 offen offset:1024 sc1 lds
  buffer_load_dwordx4 v3, s[20:23], s34 offen offset:2048 sc1 lds
  buffer_load_dwordx4 v3, s[20:23], s34 offen offset:3072 sc1 lds
  s_add_u32 s34, s31, 4194304
  s_mov_b32 m0, 73728
  s_nop 0
  buffer_load_dwordx4 v3, s[20:23], s34 offen sc1 lds
  buffer_load_dwordx4 v3, s[20:23], s34 offen offset:1024 sc1 lds
  buffer_load_dwordx4 v3, s[20:23], s34 offen offset:2048 sc1 lds
  buffer_load_dwordx4 v3, s[20:23], s34 offen offset:3072 sc1 lds
  s_add_u32 s34, s31, 4198400
  s_mov_b32 m0, 77824
  s_nop 0
  buffer_load_dwordx4 v3, s[20:23], s34 offen sc1 lds
  buffer_load_dwordx4 v3, s[20:23], s34 offen offset:1024 sc1 lds
  buffer_load_dwordx4 v3, s[20:23], s34 offen offset:2048 sc1 lds
  buffer_load_dwordx4 v3, s[20:23], s34 offen offset:3072 sc1 lds
  s_waitcnt vmcnt(16)
  s_barrier
  s_waitcnt vmcnt(0)
  v_mov_b32 v5, 1
  ds_write_b32 v4, v5
  s_mov_b32 s31, 2
  s_and_b32 s31, s31, 7
  s_lshl_b32 s31, s31, 13
  s_add_u32 s31, s31, s33
  s_add_u32 s34, s31, 2097152
  s_mov_b32 m0, 16384
  s_nop 0
  buffer_load_dwordx4 v3, s[20:23], s34 offen sc1 lds
  buffer_load_dwordx4 v3, s[20:23], s34 offen offset:1024 sc1 lds
  buffer_load_dwordx4 v3, s[20:23], s34 offen offset:2048 sc1 lds
  buffer_load_dwordx4 v3, s[20:23], s34 offen offset:3072 sc1 lds
  s_add_u32 s34, s31, 2101248
  s_mov_b32 m0, 20480
  s_nop 0
  buffer_load_dwordx4 v3, s[20:23], s34 offen sc1 lds
  buffer_load_dwordx4 v3, s[20:23], s34 offen offset:1024 sc1 lds
  buffer_load_dwordx4 v3, s[20:23], s34 offen offset:2048 sc1 lds
  buffer_load_dwordx4 v3, s[20:23], s34 offen offset:3072 sc1 lds
  s_add_u32 s34, s31, 4194304
  s_mov_b32 m0, 81920
  s_nop 0
  buffer_load_dwordx4 v3, s[20:23], s34 offen sc1 lds
  buffer_load_dwordx4 v3, s[20:23], s34 offen offset:1024 sc1 lds
  buffer_load_dwordx4 v3, s[20:23], s34 offen offset:2048 sc1 lds
  buffer_load_dwordx4 v3, s[20:23], s34 offen offset:3072 sc1 lds
  s_add_u32 s34, s31, 4198400
  s_mov_b32 m0, 86016
  s_nop 0
  buffer_load_dwordx4 v3, s[20:23], s34 offen sc1 lds
  buffer_load_dwordx4 v3, s[20:23], s34 offen offset:1024 sc1 lds
  buffer_load_dwordx4 v3, s[20:23], s34 offen offset:2048 sc1 lds
  buffer_load_dwordx4 v3, s[20:23], s34 offen offset:3072 sc1 lds
  s_waitcnt vmcnt(0)
  v_mov_b32 v5, 2
  ds_write_b32 v4, v5
  s_mov_b32 s31, 3
  s_and_b32 s31, s31, 7
  s_lshl_b32 s31, s31, 13
  s_add_u32 s31, s31, s33
  s_add_u32 s34, s31, 2097152
  s_mov_b32 m0, 24576
  s_nop 0
  buffer_load_dwordx4 v3, s[20:23], s34 offen sc1 lds
  buffer_load_dwordx4 v3, s[20:23], s34 offen offset:1024 sc1 lds
  buffer_load_dwordx4 v3, s[20:23], s34 offen offset:2048 sc1 lds
  buffer_load_dwordx4 v3, s[20:23], s34 offen offset:3072 sc1 lds
  s_add_u32 s34, s31, 2101248
  s_mov_b32 m0, 28672
  s_nop 0
  buffer_load_dwordx4 v3, s[20:23], s34 offen sc1 lds
  buffer_load_dwordx4 v3, s[20:23], s34 offen offset:1024 sc1 lds
  buffer_load_dwordx4 v3, s[20:23], s34 offen offset:2048 sc1 lds
  buffer_load_dwordx4 v3, s[20:23], s34 offen offset:3072 sc1 lds
  s_add_u32 s34, s31, 4194304
  s_mov_b32 m0, 90112
  s_nop 0
  buffer_load_dwordx4 v3, s[20:23], s34 offen sc1 lds
  buffer_load_dwordx4 v3, s[20:23], s34 offen offset:1024 sc1 lds
  buffer_load_dwordx4 v3, s[20:23], s34 offen offset:2048 sc1 lds
  buffer_load_dwordx4 v3, s[20:23], s34 offen offset:3072 sc1 lds
  s_add_u32 s34, s31, 4198400
  s_mov_b32 m0, 94208
  s_nop 0
  buffer_load_dwordx4 v3, s[20:23], s34 offen sc1 lds
  buffer_load_dwordx4 v3, s[20:23], s34 offen offset:1024 sc1 lds
  buffer_load_dwordx4 v3, s[20:23], s34 offen offset:2048 sc1 lds
  buffer_load_dwordx4 v3, s[20:23], s34 offen offset:3072 sc1 lds
  s_waitcnt vmcnt(0)
  v_mov_b32 v5, 3
  ds_write_b32 v4, v5
  s_mov_b32 s31, 4
  s_and_b32 s31, s31, 7
  s_lshl_b32 s31, s31, 13
  s_add_u32 s31, s31, s33
  s_add_u32 s34, s31, 2097152
  s_mov_b32 m0, 32768
  s_nop 0
  buffer_load_dwordx4 v3, s[20:23], s34 offen sc1 lds
  buffer_load_dwordx4 v3, s[20:23], s34 offen offset:1024 sc1 lds
  buffer_load_dwordx4 v3, s[20:23], s34 offen offset:2048 sc1 lds
  buffer_load_dwordx4 v3, s[20:23], s34 offen offset:3072 sc1 lds
  s_add_u32 s34, s31, 2101248
  s_mov_b32 m0, 36864
  s_nop 0
  buffer_load_dwordx4 v3, s[20:23], s34 offen sc1 lds
  buffer_load_dwordx4 v3, s[20:23], s34 offen offset:1024 sc1 lds
  buffer_load_dwordx4 v3, s[20:23], s34 offen offset:2048 sc1 lds
  buffer_load_dwordx4 v3, s[20:23], s34 offen offset:3072 sc1 lds
  s_add_u32 s34, s31, 4194304
  s_mov_b32 m0, 98304
  s_nop 0
  buffer_load_dwordx4 v3, s[20:23], s34 offen sc1 lds
  buffer_load_dwordx4 v3, s[20:23], s34 offen offset:1024 sc1 lds
  buffer_load_dwordx4 v3, s[20:23], s34 offen offset:2048 sc1 lds
  buffer_load_dwordx4 v3, s[20:23], s34 offen offset:3072 sc1 lds
  s_add_u32 s34, s31, 4198400
  s_mov_b32 m0, 102400
  s_nop 0
  buffer_load_dwordx4 v3, s[20:23], s34 offen sc1 lds
  buffer_load_dwordx4 v3, s[20:23], s34 offen offset:1024 sc1 lds
  buffer_load_dwordx4 v3, s[20:23], s34 offen offset:2048 sc1 lds
  buffer_load_dwordx4 v3, s[20:23], s34 offen offset:3072 sc1 lds
  s_waitcnt vmcnt(0)
  v_mov_b32 v5, 4
  ds_write_b32 v4, v5
  s_mov_b32 s31, 5
  s_and_b32 s31, s31, 7
  s_lshl_b32 s31, s31, 13
  s_add_u32 s31, s31, s33
  s_add_u32 s34, s31, 2097152
  s_mov_b32 m0, 40960
  s_nop 0
  buffer_load_dwordx4 v3, s[20:23], s34 offen sc1 lds
  buffer_load_dwordx4 v3, s[20:23], s34 offen offset:1024 sc1 lds
  buffer_load_dwordx4 v3, s[20:23], s34 offen offset:2048 sc1 lds
  buffer_load_dwordx4 v3, s[20:23], s34 offen offset:3072 sc1 lds
  s_add_u32 s34, s31, 2101248
  s_mov_b32 m0, 45056
  s_nop 0
  buffer_load_dwordx4 v3, s[20:23], s34 offen sc1 lds
  buffer_load_dwordx4 v3, s[20:23], s34 offen offset:1024 sc1 lds
  buffer_load_dwordx4 v3, s[20:23], s34 offen offset:2048 sc1 lds
  buffer_load_dwordx4 v3, s[20:23], s34 offen offset:3072 sc1 lds
  s_add_u32 s34, s31, 4194304
  s_mov_b32 m0, 106496
  s_nop 0
  buffer_load_dwordx4 v3, s[20:23], s34 offen sc1 lds
  buffer_load_dwordx4 v3, s[20:23], s34 offen offset:1024 sc1 lds
  buffer_load_dwordx4 v3, s[20:23], s34 offen offset:2048 sc1 lds
  buffer_load_dwordx4 v3, s[20:23], s34 offen offset:3072 sc1 lds
  s_add_u32 s34, s31, 4198400
  s_mov_b32 m0, 110592
  s_nop 0
  buffer_load_dwordx4 v3, s[20:23], s34 offen sc1 lds
  buffer_load_dwordx4 v3, s[20:23], s34 offen offset:1024 sc1 lds
  buffer_load_dwordx4 v3, s[20:23], s34 offen offset:2048 sc1 lds
  buffer_load_dwordx4 v3, s[20:23], s34 offen offset:3072 sc1 lds
  s_waitcnt vmcnt(0)
  v_mov_b32 v5, 5
  ds_write_b32 v4, v5
  s_mov_b32 s31, 6
  s_and_b32 s31, s31, 7
  s_lshl_b32 s31, s31, 13
  s_add_u32 s31, s31, s33
  s_add_u32 s34, s31, 2097152
  s_mov_b32 m0, 49152
  s_nop 0
  buffer_load_dwordx4 v3, s[20:23], s34 offen sc1 lds
  buffer_load_dwordx4 v3, s[20:23], s34 offen offset:1024 sc1 lds
  buffer_load_dwordx4 v3, s[20:23], s34 offen offset:2048 sc1 lds
  buffer_load_dwordx4 v3, s[20:23], s34 offen offset:3072 sc1 lds
  s_add_u32 s34, s31, 2101248
  s_mov_b32 m0, 53248
  s_nop 0
  buffer_load_dwordx4 v3, s[20:23], s34 offen sc1 lds
  buffer_load_dwordx4 v3, s[20:23], s34 offen offset:1024 sc1 lds
  buffer_load_dwordx4 v3, s[20:23], s34 offen offset:2048 sc1 lds
  buffer_load_dwordx4 v3, s[20:23], s34 offen offset:3072 sc1 lds
  s_add_u32 s34, s31, 4194304
  s_mov_b32 m0, 114688
  s_nop 0
  buffer_load_dwordx4 v3, s[20:23], s34 offen sc1 lds
  buffer_load_dwordx4 v3, s[20:23], s34 offen offset:1024 sc1 lds
  buffer_load_dwordx4 v3, s[20:23], s34 offen offset:2048 sc1 lds
  buffer_load_dwordx4 v3, s[20:23], s34 offen offset:3072 sc1 lds
  s_add_u32 s34, s31, 4198400
  s_mov_b32 m0, 118784
  s_nop 0
  buffer_load_dwordx4 v3, s[20:23], s34 offen sc1 lds
  buffer_load_dwordx4 v3, s[20:23], s34 offen offset:1024 sc1 lds
  buffer_load_dwordx4 v3, s[20:23], s34 offen offset:2048 sc1 lds
  buffer_load_dwordx4 v3, s[20:23], s34 offen offset:3072 sc1 lds
  s_waitcnt vmcnt(0)
  v_mov_b32 v5, 6
  ds_write_b32 v4, v5
  s_mov_b32 s31, 7
  s_and_b32 s31, s31, 7
  s_lshl_b32 s31, s31, 13
  s_add_u32 s31, s31, s33
  s_add_u32 s34, s31, 2097152
  s_mov_b32 m0, 57344
  s_nop 0
  buffer_load_dwordx4 v3, s[20:23], s34 offen sc1 lds
  buffer_load_dwordx4 v3, s[20:23], s34 offen offset:1024 sc1 lds
  buffer_load_dwordx4 v3, s[20:23], s34 offen offset:2048 sc1 lds
  buffer_load_dwordx4 v3, s[20:23], s34 offen offset:3072 sc1 lds
  s_add_u32 s34, s31, 2101248
  s_mov_b32 m0, 61440
  s_nop 0
  buffer_load_dwordx4 v3, s[20:23], s34 offen sc1 lds
  buffer_load_dwordx4 v3, s[20:23], s34 offen offset:1024 sc1 lds
  buffer_load_dwordx4 v3, s[20:23], s34 offen offset:2048 sc1 lds
  buffer_load_dwordx4 v3, s[20:23], s34 offen offset:3072 sc1 lds
  s_add_u32 s34, s31, 4194304
  s_mov_b32 m0, 122880
  s_nop 0
  buffer_load_dwordx4 v3, s[20:23], s34 offen sc1 lds
  buffer_load_dwordx4 v3, s[20:23], s34 offen offset:1024 sc1 lds
  buffer_load_dwordx4 v3, s[20:23], s34 offen offset:2048 sc1 lds
  buffer_load_dwordx4 v3, s[20:23], s34 offen offset:3072 sc1 lds
  s_add_u32 s34, s31, 4198400
  s_mov_b32 m0, 126976
  s_nop 0
  buffer_load_dwordx4 v3, s[20:23], s34 offen sc1 lds
  buffer_load_dwordx4 v3, s[20:23], s34 offen offset:1024 sc1 lds
  buffer_load_dwordx4 v3, s[20:23], s34 offen offset:2048 sc1 lds
  buffer_load_dwordx4 v3, s[20:23], s34 offen offset:3072 sc1 lds
  s_waitcnt vmcnt(0)
  v_mov_b32 v5, 64
  ds_write_b32 v4, v5
  s_setprio 3
  s_and_b32 s59, s3, 1
  s_xor_b32 s59, s59, 1
  s_mov_b32 s55, 0
  s_mov_b32 s40, 26226688
  s_mov_b32 exec_lo, 0xff
  s_mov_b32 exec_hi, 0
  v_lshlrev_b32 v9, 8, v2
  s_mov_b32 s41, 0
sequential_preLN__softmax_full_mha__glu_gated_reglu__prompt_kernel_t2a80:
  s_sleep 32
  buffer_load_dword v10, v9, s[20:23], s40 offen sc1
  ds_read_b32 v11, v4 offset:32
  s_waitcnt vmcnt(0) lgkmcnt(0)
  v_readfirstlane_b32 s41, v11
  v_cmp_gt_u32 vcc, 32, v10
  s_cmp_ge_u32 s41, 6
  s_cbranch_scc1 sequential_preLN__softmax_full_mha__glu_gated_reglu__prompt_kernel_t2s81
  s_cmp_lg_u64 vcc, 0
  s_cbranch_scc1 sequential_preLN__softmax_full_mha__glu_gated_reglu__prompt_kernel_t2a80
  s_mov_b32 s55, 1
  s_mov_b64 exec, -1
  s_lshr_b32 s44, s25, 2
  s_lshl_b32 s44, s44, 16
  s_add_u32 s44, s44, 18874368
  s_add_u32 s46, s44, 0
  s_mov_b32 m0, 132096
  s_nop 0
  buffer_load_dwordx4 v3, s[20:23], s46 offen sc1 lds
  s_add_u32 s46, s44, 1024
  s_mov_b32 m0, 136192
  s_nop 0
  buffer_load_dwordx4 v3, s[20:23], s46 offen sc1 lds
  s_add_u32 s46, s44, 2048
  s_mov_b32 m0, 140288
  s_nop 0
  buffer_load_dwordx4 v3, s[20:23], s46 offen sc1 lds
  s_add_u32 s46, s44, 3072
  s_mov_b32 m0, 144384
  s_nop 0
  buffer_load_dwordx4 v3, s[20:23], s46 offen sc1 lds
  s_add_u32 s46, s44, 4096
  s_mov_b32 m0, 148480
  s_nop 0
  buffer_load_dwordx4 v3, s[20:23], s46 offen sc1 lds
  s_add_u32 s46, s44, 5120
  s_mov_b32 m0, 152576
  s_nop 0
  buffer_load_dwordx4 v3, s[20:23], s46 offen sc1 lds
  s_add_u32 s46, s44, 6144
  s_mov_b32 m0, 156672
  s_nop 0
  buffer_load_dwordx4 v3, s[20:23], s46 offen sc1 lds
  s_add_u32 s46, s44, 32768
  s_mov_b32 m0, 133120
  s_nop 0
  buffer_load_dwordx4 v3, s[20:23], s46 offen sc1 lds
  s_add_u32 s46, s44, 33792
  s_mov_b32 m0, 137216
  s_nop 0
  buffer_load_dwordx4 v3, s[20:23], s46 offen sc1 lds
  s_add_u32 s46, s44, 34816
  s_mov_b32 m0, 141312
  s_nop 0
  buffer_load_dwordx4 v3, s[20:23], s46 offen sc1 lds
  s_add_u32 s46, s44, 35840
  s_mov_b32 m0, 145408
  s_nop 0
  buffer_load_dwordx4 v3, s[20:23], s46 offen sc1 lds
  s_add_u32 s46, s44, 36864
  s_mov_b32 m0, 149504
  s_nop 0
  buffer_load_dwordx4 v3, s[20:23], s46 offen sc1 lds
  s_add_u32 s46, s44, 37888
  s_mov_b32 m0, 153600
  s_nop 0
  buffer_load_dwordx4 v3, s[20:23], s46 offen sc1 lds
  s_add_u32 s46, s44, 38912
  s_mov_b32 m0, 157696
  s_nop 0
  buffer_load_dwordx4 v3, s[20:23], s46 offen sc1 lds
  s_add_u32 s46, s44, 16384
  s_mov_b32 m0, 134144
  s_nop 0
  buffer_load_dwordx4 v3, s[20:23], s46 offen sc1 lds
  s_add_u32 s46, s44, 17408
  s_mov_b32 m0, 138240
  s_nop 0
  buffer_load_dwordx4 v3, s[20:23], s46 offen sc1 lds
  s_add_u32 s46, s44, 18432
  s_mov_b32 m0, 142336
  s_nop 0
  buffer_load_dwordx4 v3, s[20:23], s46 offen sc1 lds
  s_add_u32 s46, s44, 19456
  s_mov_b32 m0, 146432
  s_nop 0
  buffer_load_dwordx4 v3, s[20:23], s46 offen sc1 lds
  s_add_u32 s46, s44, 20480
  s_mov_b32 m0, 150528
  s_nop 0
  buffer_load_dwordx4 v3, s[20:23], s46 offen sc1 lds
  s_add_u32 s46, s44, 21504
  s_mov_b32 m0, 154624
  s_nop 0
  buffer_load_dwordx4 v3, s[20:23], s46 offen sc1 lds
  s_add_u32 s46, s44, 22528
  s_mov_b32 m0, 158720
  s_nop 0
  buffer_load_dwordx4 v3, s[20:23], s46 offen sc1 lds
  s_add_u32 s46, s44, 49152
  s_mov_b32 m0, 135168
  s_nop 0
  buffer_load_dwordx4 v3, s[20:23], s46 offen sc1 lds
  s_add_u32 s46, s44, 50176
  s_mov_b32 m0, 139264
  s_nop 0
  buffer_load_dwordx4 v3, s[20:23], s46 offen sc1 lds
  s_add_u32 s46, s44, 51200
  s_mov_b32 m0, 143360
  s_nop 0
  buffer_load_dwordx4 v3, s[20:23], s46 offen sc1 lds
  s_add_u32 s46, s44, 52224
  s_mov_b32 m0, 147456
  s_nop 0
  buffer_load_dwordx4 v3, s[20:23], s46 offen sc1 lds
  s_add_u32 s46, s44, 53248
  s_mov_b32 m0, 151552
  s_nop 0
  buffer_load_dwordx4 v3, s[20:23], s46 offen sc1 lds
  s_add_u32 s46, s44, 54272
  s_mov_b32 m0, 155648
  s_nop 0
  buffer_load_dwordx4 v3, s[20:23], s46 offen sc1 lds
  s_add_u32 s46, s44, 55296
  s_mov_b32 m0, 159744
  s_nop 0
  buffer_load_dwordx4 v3, s[20:23], s46 offen sc1 lds
  s_mov_b32 s46, 25755648
  s_mov_b32 m0, 160768
  s_nop 0
  buffer_load_dwordx4 v3, s[20:23], s46 offen sc1 lds
  buffer_load_dwordx4 v3, s[20:23], s46 offen offset:1024 sc1 lds
  v_mov_b32 v5, 1
  s_waitcnt vmcnt(0)
  ds_write_b32 v4, v5 offset:20
  s_mul_i32 s42, s25, 16384
  s_add_u32 s42, s42, 18874368
  v_lshlrev_b32 v12, 7, v2
  s_add_u32 s41, s42, 0
  buffer_load_dword v40, v12, s[20:23], s41 offen sc1
  s_add_u32 s41, s42, 8192
  buffer_load_dword v41, v12, s[20:23], s41 offen sc1
  s_mov_b64 exec, -1
  s_mul_i32 s42, s25, 44032
  s_add_u32 s42, s42, 19922944
  v_lshlrev_b32 v12, 7, v2
  s_add_u32 s41, s42, 0
  buffer_load_dword v40, v12, s[20:23], s41 offen sc1
  s_add_u32 s41, s42, 8192
  buffer_load_dword v41, v12, s[20:23], s41 offen sc1
  s_add_u32 s41, s42, 16384
  buffer_load_dword v42, v12, s[20:23], s41 offen sc1
  s_add_u32 s41, s42, 24576
  buffer_load_dword v43, v12, s[20:23], s41 offen sc1
  s_add_u32 s41, s42, 32768
  buffer_load_dword v44, v12, s[20:23], s41 offen sc1
  s_mov_b32 exec_lo, 0xffffff
  s_mov_b32 exec_hi, 0x0
  s_add_u32 s41, s42, 40960
  buffer_load_dword v45, v12, s[20:23], s41 offen sc1
  s_mov_b64 exec, -1
  s_mul_i32 s42, s25, 44032
  s_add_u32 s42, s42, 21331968
  v_lshlrev_b32 v12, 7, v2
  s_add_u32 s41, s42, 0
  buffer_load_dword v40, v12, s[20:23], s41 offen sc1
  s_add_u32 s41, s42, 8192
  buffer_load_dword v41, v12, s[20:23], s41 offen sc1
  s_add_u32 s41, s42, 16384
  buffer_load_dword v42, v12, s[20:23], s41 offen sc1
  s_add_u32 s41, s42, 24576
  buffer_load_dword v43, v12, s[20:23], s41 offen sc1
  s_add_u32 s41, s42, 32768
  buffer_load_dword v44, v12, s[20:23], s41 offen sc1
  s_mov_b32 exec_lo, 0xffffff
  s_mov_b32 exec_hi, 0x0
  s_add_u32 s41, s42, 40960
  buffer_load_dword v45, v12, s[20:23], s41 offen sc1
  s_mov_b64 exec, -1
sequential_preLN__softmax_full_mha__glu_gated_reglu__prompt_kernel_t2s81:
  s_mov_b64 exec, -1
  s_lshl_b32 s43, s24, 5
  s_add_u32 s43, s43, 256
  s_lshl_b32 s42, s63, 5
  s_add_u32 s42, s42, s62
  s_add_u32 s42, s42, 256
  s_lshl_b32 s39, s42, 7
  s_add_u32 s39, s39, 26279936
  s_mov_b64 exec, 1
  v_mov_b32 v14, 1
  v_mov_b32 v15, 0
  s_waitcnt lgkmcnt(0)
  s_barrier
  buffer_store_dword v14, v15, s[20:23], s39 offen sc1
  s_cmp_eq_u32 s55, 1
  s_cbranch_scc1 sequential_preLN__softmax_full_mha__glu_gated_reglu__prompt_kernel_cwseen83
  s_mov_b32 s42, 48
  s_lshl_b32 s40, s42, 8
  s_add_u32 s40, s40, 26214400
  s_mov_b32 exec_lo, 0xff
  s_mov_b32 exec_hi, 0
  v_lshlrev_b32 v9, 8, v2
  s_mov_b32 s41, 0
sequential_preLN__softmax_full_mha__glu_gated_reglu__prompt_kernel_poll84:
  buffer_load_dword v10, v9, s[20:23], s40 offen sc1
  s_add_u32 s41, s41, 1
  s_cmp_gt_u32 s41, 0x40000
  s_cbranch_scc1 sequential_preLN__softmax_full_mha__glu_gated_reglu__prompt_kernel_pollx85
  s_waitcnt vmcnt(0)
  v_cmp_gt_u32 vcc, 32, v10
  s_cmp_eq_u64 vcc, 0
  s_cbranch_scc1 sequential_preLN__softmax_full_mha__glu_gated_reglu__prompt_kernel_pollx85
  s_branch sequential_preLN__softmax_full_mha__glu_gated_reglu__prompt_kernel_poll84
sequential_preLN__softmax_full_mha__glu_gated_reglu__prompt_kernel_pollx85:
  s_waitcnt vmcnt(0)
  s_mov_b64 exec, -1
sequential_preLN__softmax_full_mha__glu_gated_reglu__prompt_kernel_cwseen83:
  s_barrier
  s_lshl_b32 s40, s43, 7
  s_add_u32 s40, s40, 26279936
  s_mov_b32 exec_lo, 0xffffffff
  s_mov_b32 exec_hi, 0
  v_lshlrev_b32 v9, 7, v2
  s_mov_b32 s41, 0
sequential_preLN__softmax_full_mha__glu_gated_reglu__prompt_kernel_poll86:
  buffer_load_dword v10, v9, s[20:23], s40 offen sc1
  s_add_u32 s41, s41, 1
  s_cmp_gt_u32 s41, 0x40000
  s_cbranch_scc1 sequential_preLN__softmax_full_mha__glu_gated_reglu__prompt_kernel_pollx87
  s_waitcnt vmcnt(0)
  v_cmp_gt_u32 vcc, 1, v10
  s_cmp_eq_u64 vcc, 0
  s_cbranch_scc1 sequential_preLN__softmax_full_mha__glu_gated_reglu__prompt_kernel_pollx87
  s_sleep 2
  s_branch sequential_preLN__softmax_full_mha__glu_gated_reglu__prompt_kernel_poll86
sequential_preLN__softmax_full_mha__glu_gated_reglu__prompt_kernel_pollx87:
  s_waitcnt vmcnt(0)
  s_mov_b64 exec, -1
  s_barrier
  s_lshl_b32 s27, s24, 2
  s_and_b32 s28, s25, 3
  s_add_u32 s27, s27, s28
  s_lshr_b32 s28, s25, 2
  s_lshr_b32 s43, s27, 1
  s_and_b32 s44, s27, 1
  s_lshl_b32 s45, s28, 1
  s_add_u32 s44, s44, s45
  s_lshl_b32 s42, s43, 4
  s_add_u32 s42, s42, s44
  s_add_u32 s42, s42, 512
  s_lshl_b32 s39, s42, 7
  s_add_u32 s39, s39, 26279936
  s_mov_b64 exec, 1
  v_mov_b32 v14, 1
  v_mov_b32 v15, 0
  s_lshl_b32 s27, s24, 1
  s_cmp_ge_u32 s25, 15
  s_cselect_b32 s28, 1, 0
  s_add_u32 s27, s27, s28
  s_mul_i32 s28, s28, 15
  s_sub_u32 s28, s25, s28
  s_min_u32 s28, s28, 15
  s_lshl_b32 s46, s27, 4
  s_add_u32 s42, s46, 512
  s_barrier
  s_barrier
  s_cmp_eq_u32 s59, 1
  s_cbranch_scc1 sequential_preLN__softmax_full_mha__glu_gated_reglu__prompt_kernel_ps88
  buffer_store_dword v14, v15, s[20:23], s39 offen sc1
  s_branch sequential_preLN__softmax_full_mha__glu_gated_reglu__prompt_kernel_pe89
sequential_preLN__softmax_full_mha__glu_gated_reglu__prompt_kernel_ps88:
  buffer_store_dword v14, v15, s[20:23], s39 offen
sequential_preLN__softmax_full_mha__glu_gated_reglu__prompt_kernel_pe89:
  s_cmp_eq_u32 s28, 15
  s_cbranch_scc1 sequential_preLN__softmax_full_mha__glu_gated_reglu__prompt_kernel_pidle90
  s_lshl_b32 s47, s27, 17
  s_add_u32 s47, s47, 10485760
  s_lshl_b32 s40, s42, 7
  s_add_u32 s40, s40, 26279936
  s_mov_b32 exec_lo, 0xffff
  s_mov_b32 exec_hi, 0
  v_lshlrev_b32 v9, 7, v2
  s_mov_b32 s41, 0
sequential_preLN__softmax_full_mha__glu_gated_reglu__prompt_kernel_poll91:
  buffer_load_dword v10, v9, s[20:23], s40 offen sc1
  s_add_u32 s41, s41, 1
  s_cmp_gt_u32 s41, 0x40000
  s_cbranch_scc1 sequential_preLN__softmax_full_mha__glu_gated_reglu__prompt_kernel_pollx92
  s_waitcnt vmcnt(0)
  v_cmp_gt_u32 vcc, 1, v10
  s_cmp_eq_u64 vcc, 0
  s_cbranch_scc1 sequential_preLN__softmax_full_mha__glu_gated_reglu__prompt_kernel_pollx92
  s_sleep 2
  s_branch sequential_preLN__softmax_full_mha__glu_gated_reglu__prompt_kernel_poll91
sequential_preLN__softmax_full_mha__glu_gated_reglu__prompt_kernel_pollx92:
  s_waitcnt vmcnt(0)
  s_mov_b64 exec, -1
  s_add_u32 s48, s47, 0
  s_mov_b32 m0, 12288
  s_nop 0
  buffer_load_dwordx4 v3, s[20:23], s48 offen sc1 lds
  buffer_load_dwordx4 v3, s[20:23], s48 offen offset:1024 sc1 lds
  s_add_u32 s48, s47, 32768
  s_mov_b32 m0, 14336
  s_nop 0
  buffer_load_dwordx4 v3, s[20:23], s48 offen sc1 lds
  buffer_load_dwordx4 v3, s[20:23], s48 offen offset:1024 sc1 lds
  s_add_u32 s48, s47, 65536
  s_mov_b32 m0, 16384
  s_nop 0
  buffer_load_dwordx4 v3, s[20:23], s48 offen sc1 lds
  buffer_load_dwordx4 v3, s[20:23], s48 offen offset:1024 sc1 lds
  s_add_u32 s48, s47, 98304
  s_mov_b32 m0, 18432
  s_nop 0
  buffer_load_dwordx4 v3, s[20:23], s48 offen sc1 lds
  buffer_load_dwordx4 v3, s[20:23], s48 offen offset:1024 sc1 lds
  s_barrier
  s_add_u32 s42, s46, s28
  s_add_u32 s42, s42, 768
  s_lshl_b32 s39, s42, 7
  s_add_u32 s39, s39, 26279936
  s_mov_b64 exec, 1
  v_mov_b32 v14, 1
  v_mov_b32 v15, 0
  s_waitcnt vmcnt(0)
  s_barrier
  s_barrier
  s_barrier
  s_barrier
  s_barrier
  s_barrier
  s_barrier
  s_barrier
  s_barrier
  s_barrier
  s_barrier
  s_barrier
  s_barrier
  s_barrier
  s_barrier
  s_barrier
  s_barrier
  s_barrier
  s_cmp_eq_u32 s59, 1
  s_cbranch_scc1 sequential_preLN__softmax_full_mha__glu_gated_reglu__prompt_kernel_ps93
  buffer_store_dword v14, v15, s[20:23], s39 offen sc1
  s_branch sequential_preLN__softmax_full_mha__glu_gated_reglu__prompt_kernel_pe94
sequential_preLN__softmax_full_mha__glu_gated_reglu__prompt_kernel_ps93:
  buffer_store_dword v14, v15, s[20:23], s39 offen
sequential_preLN__softmax_full_mha__glu_gated_reglu__prompt_kernel_pe94:
  s_branch sequential_preLN__softmax_full_mha__glu_gated_reglu__prompt_kernel_pjoin95
sequential_preLN__softmax_full_mha__glu_gated_reglu__prompt_kernel_pidle90:
  s_barrier
sequential_preLN__softmax_full_mha__glu_gated_reglu__prompt_kernel_pjoin95:
  s_lshl_b32 s42, s43, 4
  s_add_u32 s42, s42, 768
  s_lshl_b32 s40, s42, 7
  s_add_u32 s40, s40, 26279936
  s_mov_b32 exec_lo, 0x7fff
  s_mov_b32 exec_hi, 0
  v_lshlrev_b32 v9, 7, v2
  s_mov_b32 s41, 0
sequential_preLN__softmax_full_mha__glu_gated_reglu__prompt_kernel_poll96:
  buffer_load_dword v10, v9, s[20:23], s40 offen sc1
  s_add_u32 s41, s41, 1
  s_cmp_gt_u32 s41, 0x40000
  s_cbranch_scc1 sequential_preLN__softmax_full_mha__glu_gated_reglu__prompt_kernel_pollx97
  s_waitcnt vmcnt(0)
  v_cmp_gt_u32 vcc, 1, v10
  s_cmp_eq_u64 vcc, 0
  s_cbranch_scc1 sequential_preLN__softmax_full_mha__glu_gated_reglu__prompt_kernel_pollx97
  s_sleep 2
  s_branch sequential_preLN__softmax_full_mha__glu_gated_reglu__prompt_kernel_poll96
sequential_preLN__softmax_full_mha__glu_gated_reglu__prompt_kernel_pollx97:
  s_waitcnt vmcnt(0)
  s_mov_b64 exec, -1
  s_barrier
  s_endpgm
sequential_preLN__softmax_full_mha__glu_gated_reglu__prompt_kernel_RL17:
  v_mov_b32 v1, 163832
  ds_read_b32 v1, v1
  s_waitcnt lgkmcnt(0)
  v_readfirstlane_b32 s0, v1
  s_nop 0
  s_cmp_eq_u32 s0, 0
  s_cbranch_scc1 sequential_preLN__softmax_full_mha__glu_gated_reglu__prompt_kernel_rok98
  s_branch sequential_preLN__softmax_full_mha__glu_gated_reglu__prompt_kernel_redo
sequential_preLN__softmax_full_mha__glu_gated_reglu__prompt_kernel_rok98:
  s_lshl_b32 s62, s24, 2
  s_and_b32 s63, s25, 3
  s_add_u32 s62, s62, s63
  s_lshr_b32 s63, s25, 2
  s_sub_u32 s29, s26, 9
  s_cmp_lg_u32 s26, 9
  s_cbranch_scc1 sequential_preLN__softmax_full_mha__glu_gated_reglu__prompt_kernel_pe99
  s_mov_b32 s34, s24
  s_mov_b32 s35, s25
  s_getreg_b32 s24, hwreg(HW_REG_XCC_ID, 0, 3)
  s_getreg_b32 s25, hwreg(HW_REG_HW_ID, 13, 2)
  s_lshl_b32 s25, s25, 3
  s_lshl_b32 s30, s24, 2
  s_lshr_b32 s31, s25, 3
  s_add_u32 s30, s30, s31
  s_lshl_b32 s30, s30, 7
  s_add_u32 s30, s30, 26247168
  s_lshl_b32 s31, s1, 3
  s_mov_b64 exec, 1
  v_mov_b32 v50, s31
  v_mov_b32 v52, 0
  v_mov_b32 v53, 0
  buffer_store_dwordx2 v[52:53], v50, s[20:23], s30 offen
  s_mov_b64 exec, -1
  s_mov_b32 s24, s34
  s_mov_b32 s25, s35
sequential_preLN__softmax_full_mha__glu_gated_reglu__prompt_kernel_pe99:
  s_waitcnt lgkmcnt(0)
  s_barrier
  s_barrier
  v_and_b32 v6, 31, v2
  v_lshrrev_b32 v7, 5, v2
  v_lshlrev_b32 v12, 10, v6
  v_lshl_add_u32 v12, v7, 3, v12
  v_mul_u32_u24 v13, 11008, v7
  v_lshl_add_u32 v13, v6, 1, v13
  v_lshlrev_b32 v14, 12, v7
  v_lshl_add_u32 v14, v6, 1, v14
  s_lshl_b32 s42, s2, 3
  s_mul_i32 s43, s29, 3
  s_add_u32 s42, s42, s43
  s_add_u32 s39, s42, 0
  s_mov_b32 s44, s4
  s_and_b32 s45, s5, 0xffff
  s_mov_b32 s46, 2097152
  s_mov_b32 s47, 0x20000
  s_lshr_b32 s43, s39, 5
  s_lshl_b32 s43, s43, 15
  s_and_b32 s48, s39, 31
  s_lshl_b32 s48, s48, 5
  s_add_u32 s43, s43, s48
  buffer_load_dwordx2 v[16:17], v12, s[44:47], s43 offen
  buffer_load_dwordx2 v[18:19], v12, s[44:47], s43 offen offset:16
  s_mov_b32 s50, 99882961
  s_mul_hi_u32 s51, s39, s50
  s_mul_i32 s58, s51, 43
  s_sub_u32 s58, s39, s58
  s_mul_i32 s59, s51, 44032
  s_lshl_b32 s48, s58, 6
  s_add_u32 s59, s59, s48
  s_lshl_b32 s37, s58, 6
  s_add_u32 s37, s37, s51
  s_lshl_b32 s37, s37, 10
  s_cmp_lt_u32 s39, 1376
  s_cselect_b32 s50, 1409024, 0
  s_mov_b32 s44, s12
  s_and_b32 s45, s13, 0xffff
  s_mov_b32 s46, s50
  s_add_u32 s49, s59, 0
  buffer_load_ushort v20, v13, s[44:47], s49 offen
  s_add_u32 s49, s59, 2752
  buffer_load_ushort v21, v13, s[44:47], s49 offen
  s_add_u32 s49, s59, 5504
  buffer_load_ushort v22, v13, s[44:47], s49 offen
  s_add_u32 s49, s59, 8256
  buffer_load_ushort v23, v13, s[44:47], s49 offen
  s_add_u32 s49, s59, 22016
  buffer_load_ushort v24, v13, s[44:47], s49 offen
  s_add_u32 s49, s59, 24768
  buffer_load_ushort v25, v13, s[44:47], s49 offen
  s_add_u32 s49, s59, 27520
  buffer_load_ushort v26, v13, s[44:47], s49 offen
  s_add_u32 s49, s59, 30272
  buffer_load_ushort v27, v13, s[44:47], s49 offen
  s_mov_b32 s44, s14
  s_and_b32 s45, s15, 0xffff
  s_add_u32 s49, s59, 0
  buffer_load_ushort v28, v13, s[44:47], s49 offen
  s_add_u32 s49, s59, 2752
  buffer_load_ushort v29, v13, s[44:47], s49 offen
  s_add_u32 s49, s59, 5504
  buffer_load_ushort v30, v13, s[44:47], s49 offen
  s_add_u32 s49, s59, 8256
  buffer_load_ushort v31, v13, s[44:47], s49 offen
  s_add_u32 s49, s59, 22016
  buffer_load_ushort v32, v13, s[44:47], s49 offen
  s_add_u32 s49, s59, 24768
  buffer_load_ushort v33, v13, s[44:47], s49 offen
  s_add_u32 s49, s59, 27520
  buffer_load_ushort v34, v13, s[44:47], s49 offen
  s_add_u32 s49, s59, 30272
  buffer_load_ushort v35, v13, s[44:47], s49 offen
  s_sub_u32 s48, s39, 1376
  s_cmp_lt_u32 s39, 1376
  s_cselect_b32 s48, s39, s48
  s_cselect_b32 s44, s16, s8
  s_cselect_b32 s45, s17, s9
  s_cselect_b32 s46, 1409024, 0
  s_cselect_b32 s50, 86, 32
  s_cselect_b32 s43, 4194304, 0
  s_and_b32 s45, s45, 0xffff
  s_sub_u32 s51, s39, 1376
  s_cmp_lt_u32 s51, 512
  s_cselect_b32 s46, 524288, s46
  s_and_b32 s58, s48, 15
  s_lshr_b32 s51, s48, 4
  s_lshl_b32 s59, s51, 14
  s_lshl_b32 s48, s58, 6
  s_add_u32 s59, s59, s48
  s_mul_i32 s38, s58, s50
  s_add_u32 s38, s38, s51
  s_lshl_b32 s38, s38, 10
  s_add_u32 s38, s38, s43
  s_add_u32 s49, s59, 0
  buffer_load_ushort v36, v14, s[44:47], s49 offen
  s_add_u32 s49, s59, 1024
  buffer_load_ushort v37, v14, s[44:47], s49 offen
  s_add_u32 s49, s59, 2048
  buffer_load_ushort v38, v14, s[44:47], s49 offen
  s_add_u32 s49, s59, 3072
  buffer_load_ushort v39, v14, s[44:47], s49 offen
  s_add_u32 s49, s59, 8192
  buffer_load_ushort v40, v14, s[44:47], s49 offen
  s_add_u32 s49, s59, 9216
  buffer_load_ushort v41, v14, s[44:47], s49 offen
  s_add_u32 s49, s59, 10240
  buffer_load_ushort v42, v14, s[44:47], s49 offen
  s_add_u32 s49, s59, 11264
  buffer_load_ushort v43, v14, s[44:47], s49 offen
  s_add_u32 s54, s42, 1
  s_mov_b32 s44, s4
  s_and_b32 s45, s5, 0xffff
  s_mov_b32 s46, 2097152
  s_mov_b32 s47, 0x20000
  s_lshr_b32 s43, s54, 5
  s_lshl_b32 s43, s43, 15
  s_and_b32 s48, s54, 31
  s_lshl_b32 s48, s48, 5
  s_add_u32 s43, s43, s48
  buffer_load_dwordx2 v[44:45], v12, s[44:47], s43 offen
  buffer_load_dwordx2 v[46:47], v12, s[44:47], s43 offen offset:16
  s_mov_b32 s50, 99882961
  s_mul_hi_u32 s51, s54, s50
  s_mul_i32 s58, s51, 43
  s_sub_u32 s58, s54, s58
  s_mul_i32 s59, s51, 44032
  s_lshl_b32 s48, s58, 6
  s_add_u32 s59, s59, s48
  s_lshl_b32 s52, s58, 6
  s_add_u32 s52, s52, s51
  s_lshl_b32 s52, s52, 10
  s_cmp_lt_u32 s54, 1376
  s_cselect_b32 s50, 1409024, 0
  s_mov_b32 s44, s12
  s_and_b32 s45, s13, 0xffff
  s_mov_b32 s46, s50
  s_add_u32 s49, s59, 0
  buffer_load_ushort v48, v13, s[44:47], s49 offen
  s_add_u32 s49, s59, 2752
  buffer_load_ushort v49, v13, s[44:47], s49 offen
  s_add_u32 s49, s59, 5504
  buffer_load_ushort v50, v13, s[44:47], s49 offen
  s_add_u32 s49, s59, 8256
  buffer_load_ushort v51, v13, s[44:47], s49 offen
  s_add_u32 s49, s59, 22016
  buffer_load_ushort v52, v13, s[44:47], s49 offen
  s_add_u32 s49, s59, 24768
  buffer_load_ushort v53, v13, s[44:47], s49 offen
  s_add_u32 s49, s59, 27520
  buffer_load_ushort v54, v13, s[44:47], s49 offen
  s_add_u32 s49, s59, 30272
  buffer_load_ushort v55, v13, s[44:47], s49 offen
  s_mov_b32 s44, s14
  s_and_b32 s45, s15, 0xffff
  s_add_u32 s49, s59, 0
  buffer_load_ushort v56, v13, s[44:47], s49 offen
  s_add_u32 s49, s59, 2752
  buffer_load_ushort v57, v13, s[44:47], s49 offen
  s_add_u32 s49, s59, 5504
  buffer_load_ushort v58, v13, s[44:47], s49 offen
  s_add_u32 s49, s59, 8256
  buffer_load_ushort v59, v13, s[44:47], s49 offen
  s_add_u32 s49, s59, 22016
  buffer_load_ushort v60, v13, s[44:47], s49 offen
  s_add_u32 s49, s59, 24768
  buffer_load_ushort v61, v13, s[44:47], s49 offen
  s_add_u32 s49, s59, 27520
  buffer_load_ushort v62, v13, s[44:47], s49 offen
  s_add_u32 s49, s59, 30272
  buffer_load_ushort v63, v13, s[44:47], s49 offen
  s_sub_u32 s48, s54, 1376
  s_cmp_lt_u32 s54, 1376
  s_cselect_b32 s48, s54, s48
  s_cselect_b32 s44, s16, s8
  s_cselect_b32 s45, s17, s9
  s_cselect_b32 s46, 1409024, 0
  s_cselect_b32 s50, 86, 32
  s_cselect_b32 s43, 4194304, 0
  s_and_b32 s45, s45, 0xffff
  s_sub_u32 s51, s54, 1376
  s_cmp_lt_u32 s51, 512
  s_cselect_b32 s46, 524288, s46
  s_and_b32 s58, s48, 15
  s_lshr_b32 s51, s48, 4
  s_lshl_b32 s59, s51, 14
  s_lshl_b32 s48, s58, 6
  s_add_u32 s59, s59, s48
  s_mul_i32 s53, s58, s50
  s_add_u32 s53, s53, s51
  s_lshl_b32 s53, s53, 10
  s_add_u32 s53, s53, s43
  s_add_u32 s49, s59, 0
  buffer_load_ushort v64, v14, s[44:47], s49 offen
  s_add_u32 s49, s59, 1024
  buffer_load_ushort v65, v14, s[44:47], s49 offen
  s_add_u32 s49, s59, 2048
  buffer_load_ushort v66, v14, s[44:47], s49 offen
  s_add_u32 s49, s59, 3072
  buffer_load_ushort v67, v14, s[44:47], s49 offen
  s_add_u32 s49, s59, 8192
  buffer_load_ushort v68, v14, s[44:47], s49 offen
  s_add_u32 s49, s59, 9216
  buffer_load_ushort v69, v14, s[44:47], s49 offen
  s_add_u32 s49, s59, 10240
  buffer_load_ushort v70, v14, s[44:47], s49 offen
  s_add_u32 s49, s59, 11264
  buffer_load_ushort v71, v14, s[44:47], s49 offen
  s_mov_b32 s44, s8
  s_and_b32 s45, s9, 0xffff
  s_mov_b32 s46, 524288
  s_mov_b32 s47, 0x20000
  s_and_b32 s35, s29, 1
  s_lshl_b32 s36, s2, 1
  s_add_u32 s35, s35, s36
  s_lshl_b32 s36, s35, 10
  buffer_load_dwordx4 v[72:75], v3, s[44:47], s36 offen
  s_waitcnt vmcnt(27)
  s_lshl_b32 s43, s39, 10
  s_add_u32 s43, s43, 8388608
  buffer_store_dwordx4 v[16:19], v3, s[20:23], s43 offen sc1
  s_cmp_lt_u32 s39, 1376
  s_cbranch_scc0 sequential_preLN__softmax_full_mha__glu_gated_reglu__prompt_kernel_is1100
  v_lshl_or_b32 v20, v21, 16, v20
  v_lshl_or_b32 v21, v23, 16, v22
  v_lshl_or_b32 v22, v25, 16, v24
  v_lshl_or_b32 v23, v27, 16, v26
  v_lshl_or_b32 v28, v29, 16, v28
  v_lshl_or_b32 v29, v31, 16, v30
  v_lshl_or_b32 v30, v33, 16, v32
  v_lshl_or_b32 v31, v35, 16, v34
  s_nop 1
  v_permlane16_swap_b32 v20, v28
  v_permlane16_swap_b32 v21, v29
  v_permlane16_swap_b32 v22, v30
  v_permlane16_swap_b32 v23, v31
  s_add_u32 s49, s37, 19922944
  buffer_store_dwordx4 v[20:23], v3, s[20:23], s49 offen sc1
  s_add_u32 s49, s37, 19955712
  buffer_store_dwordx4 v[28:31], v3, s[20:23], s49 offen sc1
sequential_preLN__softmax_full_mha__glu_gated_reglu__prompt_kernel_is1100:
  s_cmp_lt_u32 s39, 1888
  s_cbranch_scc0 sequential_preLN__softmax_full_mha__glu_gated_reglu__prompt_kernel_is2101
  v_lshl_or_b32 v36, v37, 16, v36
  v_lshl_or_b32 v37, v39, 16, v38
  v_lshl_or_b32 v38, v41, 16, v40
  v_lshl_or_b32 v39, v43, 16, v42
  s_add_u32 s49, s38, 18874368
  buffer_store_dwordx4 v[36:39], v3, s[20:23], s49 offen sc1
sequential_preLN__softmax_full_mha__glu_gated_reglu__prompt_kernel_is2101:
  s_add_u32 s34, s42, 2
  s_cmp_eq_u32 s29, 2
  s_cselect_b32 s34, 0xfff, s34
  s_mov_b32 s44, s4
  s_and_b32 s45, s5, 0xffff
  s_mov_b32 s46, 2097152
  s_mov_b32 s47, 0x20000
  s_lshr_b32 s43, s34, 5
  s_lshl_b32 s43, s43, 15
  s_and_b32 s48, s34, 31
  s_lshl_b32 s48, s48, 5
  s_add_u32 s43, s43, s48
  buffer_load_dwordx2 v[80:81], v12, s[44:47], s43 offen
  buffer_load_dwordx2 v[82:83], v12, s[44:47], s43 offen offset:16
  s_mov_b32 s50, 99882961
  s_mul_hi_u32 s51, s34, s50
  s_mul_i32 s58, s51, 43
  s_sub_u32 s58, s34, s58
  s_mul_i32 s59, s51, 44032
  s_lshl_b32 s48, s58, 6
  s_add_u32 s59, s59, s48
  s_lshl_b32 s32, s58, 6
  s_add_u32 s32, s32, s51
  s_lshl_b32 s32, s32, 10
  s_cmp_lt_u32 s34, 1376
  s_cselect_b32 s50, 1409024, 0
  s_mov_b32 s44, s12
  s_and_b32 s45, s13, 0xffff
  s_mov_b32 s46, s50
  s_add_u32 s49, s59, 0
  buffer_load_ushort v84, v13, s[44:47], s49 offen
  s_add_u32 s49, s59, 2752
  buffer_load_ushort v85, v13, s[44:47], s49 offen
  s_add_u32 s49, s59, 5504
  buffer_load_ushort v86, v13, s[44:47], s49 offen
  s_add_u32 s49, s59, 8256
  buffer_load_ushort v87, v13, s[44:47], s49 offen
  s_add_u32 s49, s59, 22016
  buffer_load_ushort v88, v13, s[44:47], s49 offen
  s_add_u32 s49, s59, 24768
  buffer_load_ushort v89, v13, s[44:47], s49 offen
  s_add_u32 s49, s59, 27520
  buffer_load_ushort v90, v13, s[44:47], s49 offen
  s_add_u32 s49, s59, 30272
  buffer_load_ushort v91, v13, s[44:47], s49 offen
  s_mov_b32 s44, s14
  s_and_b32 s45, s15, 0xffff
  s_add_u32 s49, s59, 0
  buffer_load_ushort v92, v13, s[44:47], s49 offen
  s_add_u32 s49, s59, 2752
  buffer_load_ushort v93, v13, s[44:47], s49 offen
  s_add_u32 s49, s59, 5504
  buffer_load_ushort v94, v13, s[44:47], s49 offen
  s_add_u32 s49, s59, 8256
  buffer_load_ushort v95, v13, s[44:47], s49 offen
  s_add_u32 s49, s59, 22016
  buffer_load_ushort v96, v13, s[44:47], s49 offen
  s_add_u32 s49, s59, 24768
  buffer_load_ushort v97, v13, s[44:47], s49 offen
  s_add_u32 s49, s59, 27520
  buffer_load_ushort v98, v13, s[44:47], s49 offen
  s_add_u32 s49, s59, 30272
  buffer_load_ushort v99, v13, s[44:47], s49 offen
  s_sub_u32 s48, s34, 1376
  s_cmp_lt_u32 s34, 1376
  s_cselect_b32 s48, s34, s48
  s_cselect_b32 s44, s16, s8
  s_cselect_b32 s45, s17, s9
  s_cselect_b32 s46, 1409024, 0
  s_cselect_b32 s50, 86, 32
  s_cselect_b32 s43, 4194304, 0
  s_and_b32 s45, s45, 0xffff
  s_sub_u32 s51, s34, 1376
  s_cmp_lt_u32 s51, 512
  s_cselect_b32 s46, 524288, s46
  s_and_b32 s58, s48, 15
  s_lshr_b32 s51, s48, 4
  s_lshl_b32 s59, s51, 14
  s_lshl_b32 s48, s58, 6
  s_add_u32 s59, s59, s48
  s_mul_i32 s33, s58, s50
  s_add_u32 s33, s33, s51
  s_lshl_b32 s33, s33, 10
  s_add_u32 s33, s33, s43
  s_add_u32 s49, s59, 0
  buffer_load_ushort v100, v14, s[44:47], s49 offen
  s_add_u32 s49, s59, 1024
  buffer_load_ushort v101, v14, s[44:47], s49 offen
  s_add_u32 s49, s59, 2048
  buffer_load_ushort v102, v14, s[44:47], s49 offen
  s_add_u32 s49, s59, 3072
  buffer_load_ushort v103, v14, s[44:47], s49 offen
  s_add_u32 s49, s59, 8192
  buffer_load_ushort v104, v14, s[44:47], s49 offen
  s_add_u32 s49, s59, 9216
  buffer_load_ushort v105, v14, s[44:47], s49 offen
  s_add_u32 s49, s59, 10240
  buffer_load_ushort v106, v14, s[44:47], s49 offen
  s_add_u32 s49, s59, 11264
  buffer_load_ushort v107, v14, s[44:47], s49 offen
  s_waitcnt vmcnt(26)
  s_lshl_b32 s43, s54, 10
  s_add_u32 s43, s43, 8388608
  buffer_store_dwordx4 v[44:47], v3, s[20:23], s43 offen sc1
  s_cmp_lt_u32 s54, 1376
  s_cbranch_scc0 sequential_preLN__softmax_full_mha__glu_gated_reglu__prompt_kernel_is1102
  v_lshl_or_b32 v48, v49, 16, v48
  v_lshl_or_b32 v49, v51, 16, v50
  v_lshl_or_b32 v50, v53, 16, v52
  v_lshl_or_b32 v51, v55, 16, v54
  v_lshl_or_b32 v56, v57, 16, v56
  v_lshl_or_b32 v57, v59, 16, v58
  v_lshl_or_b32 v58, v61, 16, v60
  v_lshl_or_b32 v59, v63, 16, v62
  s_nop 1
  v_permlane16_swap_b32 v48, v56
  v_permlane16_swap_b32 v49, v57
  v_permlane16_swap_b32 v50, v58
  v_permlane16_swap_b32 v51, v59
  s_add_u32 s49, s52, 19922944
  buffer_store_dwordx4 v[48:51], v3, s[20:23], s49 offen sc1
  s_add_u32 s49, s52, 19955712
  buffer_store_dwordx4 v[56:59], v3, s[20:23], s49 offen sc1
sequential_preLN__softmax_full_mha__glu_gated_reglu__prompt_kernel_is1102:
  s_cmp_lt_u32 s54, 1888
  s_cbranch_scc0 sequential_preLN__softmax_full_mha__glu_gated_reglu__prompt_kernel_is2103
  v_lshl_or_b32 v64, v65, 16, v64
  v_lshl_or_b32 v65, v67, 16, v66
  v_lshl_or_b32 v66, v69, 16, v68
  v_lshl_or_b32 v67, v71, 16, v70
  s_add_u32 s49, s53, 18874368
  buffer_store_dwordx4 v[64:67], v3, s[20:23], s49 offen sc1
sequential_preLN__softmax_full_mha__glu_gated_reglu__prompt_kernel_is2103:
  s_mov_b32 s36, 0x3f803f80
  v_dot2_f32_bf16 v76, v72, s36, 0
  v_dot2_f32_bf16 v76, v73, s36, v76
  v_dot2_f32_bf16 v76, v74, s36, v76
  v_dot2_f32_bf16 v76, v75, s36, v76
  s_nop 0
  s_nop 1
  v_add_f32_dpp v76, v76, v76 quad_perm:[1,0,3,2] row_mask:0xf bank_mask:0xf
  s_nop 1
  v_add_f32_dpp v76, v76, v76 quad_perm:[2,3,0,1] row_mask:0xf bank_mask:0xf
  s_nop 1
  v_add_f32_dpp v76, v76, v76 row_half_mirror row_mask:0xf bank_mask:0xf
  s_nop 1
  v_add_f32_dpp v76, v76, v76 row_mirror row_mask:0xf bank_mask:0xf
  s_nop 0
  v_readlane_b32 s48, v76, 0
  v_readlane_b32 s49, v76, 16
  v_readlane_b32 s50, v76, 32
  v_readlane_b32 s51, v76, 48
  s_lshr_b32 s36, s35, 4
  s_lshl_b32 s36, s36, 6
  s_bfe_u32 s43, s35, 0x10002
  s_lshl_b32 s43, s43, 4
  s_add_u32 s36, s36, s43
  v_mov_b32 v76, s48
  v_add_f32 v76, s49, v76
  v_add_f32 v76, s50, v76
  v_add_f32 v76, s51, v76
  v_mul_f32 v76, 0x3b000000, v76
  s_bfe_u32 s43, s35, 0x10003
  s_lshl_b32 s43, s43, 3
  s_add_u32 s36, s36, s43
  v_cvt_pk_bf16_f32 v77, v76, v76
  s_and_b32 s43, s35, 3
  s_lshl_b32 s43, s43, 1
  s_add_u32 s36, s36, s43
  v_and_b32 v78, 0xffff0000, v77
  v_sub_f32 v78, v76, v78
  s_add_u32 s36, s36, 25755648
  v_cvt_pk_bf16_f32 v78, v78, v78
  v_mov_b32 v79, 0
  s_mov_b64 exec, 1
  buffer_store_short v77, v79, s[20:23], s36 offen sc1
  buffer_store_short v78, v79, s[20:23], s36 offen offset:32 sc1
  s_mov_b64 exec, -1
  s_waitcnt vmcnt(0)
  s_cmp_eq_u32 s29, 2
  s_cbranch_scc1 sequential_preLN__softmax_full_mha__glu_gated_reglu__prompt_kernel_is2105
  s_lshl_b32 s43, s34, 10
  s_add_u32 s43, s43, 8388608
  buffer_store_dwordx4 v[80:83], v3, s[20:23], s43 offen sc1
  s_cmp_lt_u32 s34, 1376
  s_cbranch_scc0 sequential_preLN__softmax_full_mha__glu_gated_reglu__prompt_kernel_is1104
  v_lshl_or_b32 v84, v85, 16, v84
  v_lshl_or_b32 v85, v87, 16, v86
  v_lshl_or_b32 v86, v89, 16, v88
  v_lshl_or_b32 v87, v91, 16, v90
  v_lshl_or_b32 v92, v93, 16, v92
  v_lshl_or_b32 v93, v95, 16, v94
  v_lshl_or_b32 v94, v97, 16, v96
  v_lshl_or_b32 v95, v99, 16, v98
  s_nop 1
  v_permlane16_swap_b32 v84, v92
  v_permlane16_swap_b32 v85, v93
  v_permlane16_swap_b32 v86, v94
  v_permlane16_swap_b32 v87, v95
  s_add_u32 s49, s32, 19922944
  buffer_store_dwordx4 v[84:87], v3, s[20:23], s49 offen sc1
  s_add_u32 s49, s32, 19955712
  buffer_store_dwordx4 v[92:95], v3, s[20:23], s49 offen sc1
sequential_preLN__softmax_full_mha__glu_gated_reglu__prompt_kernel_is1104:
  s_cmp_lt_u32 s34, 1888
  s_cbranch_scc0 sequential_preLN__softmax_full_mha__glu_gated_reglu__prompt_kernel_is2105
  v_lshl_or_b32 v100, v101, 16, v100
  v_lshl_or_b32 v101, v103, 16, v102
  v_lshl_or_b32 v102, v105, 16, v104
  v_lshl_or_b32 v103, v107, 16, v106
  s_add_u32 s49, s33, 18874368
  buffer_store_dwordx4 v[100:103], v3, s[20:23], s49 offen sc1
sequential_preLN__softmax_full_mha__glu_gated_reglu__prompt_kernel_is2105:
  s_waitcnt vmcnt(0)
  v_mov_b32 v5, 131120
  v_mov_b32 v6, 1
  s_mov_b64 exec, 1
  ds_add_rtn_u32 v7, v5, v6
  s_waitcnt lgkmcnt(0)
  v_readfirstlane_b32 s42, v7
  s_cmp_lg_u32 s42, 2
  s_cbranch_scc1 sequential_preLN__softmax_full_mha__glu_gated_reglu__prompt_kernel_noarr106
  s_add_u32 s42, s24, 48
  s_lshl_b32 s40, s42, 8
  s_add_u32 s40, s40, 26214400
  s_mov_b64 exec, 1
  v_mov_b32 v8, 1
  v_mov_b32 v9, 0
  buffer_atomic_add v8, v9, s[20:23], s40 offen sc1
sequential_preLN__softmax_full_mha__glu_gated_reglu__prompt_kernel_noarr106:
  s_endpgm
sequential_preLN__softmax_full_mha__glu_gated_reglu__prompt_kernel_spin68:
  s_sleep 1
  ds_read_b32 v112, v6
  s_waitcnt lgkmcnt(0)
  s_branch sequential_preLN__softmax_full_mha__glu_gated_reglu__prompt_kernel_chk67
sequential_preLN__softmax_full_mha__glu_gated_reglu__prompt_kernel_fb70:
  v_mov_b32 v4, v3
  v_subrev_u32 v5, 0x10000, v5
  v_mov_b32 v7, 0xff7fffff
  v_mov_b32 v96, 0
  v_mov_b32 v97, 0
  v_mov_b32 v98, 0
  v_mov_b32 v99, 0
  v_mov_b32 v100, 0
  v_mov_b32 v101, 0
  v_mov_b32 v102, 0
  v_mov_b32 v103, 0
  v_mov_b32 v104, 0
  v_mov_b32 v105, 0
  v_mov_b32 v106, 0
  v_mov_b32 v107, 0
  v_mov_b32 v108, 0
  v_mov_b32 v109, 0
  v_mov_b32 v110, 0
  v_mov_b32 v111, 0
  s_mov_b32 s38, 0
sequential_preLN__softmax_full_mha__glu_gated_reglu__prompt_kernel_fl107:
  ds_read_b128 v[12:15], v4
  s_mov_b64 exec, s[36:37]
  ds_read_b128 v[20:23], v5 offset:0
  ds_read_b128 v[24:27], v5 offset:512
  s_mov_b64 exec, -1
  s_waitcnt lgkmcnt(0)
  v_mfma_f32_32x32x16_bf16 v[48:63], v[12:15], v[8:11], 0
  s_nop 13
  v_max3_f32 v44, v48, v49, v50
  v_max3_f32 v45, v51, v52, v53
  v_max3_f32 v44, v44, v54, v55
  v_max3_f32 v45, v45, v56, v57
  v_max3_f32 v44, v44, v58, v59
  v_max3_f32 v45, v45, v60, v61
  v_max3_f32 v44, v44, v62, v63
  v_max_f32 v45, v44, v45
  v_mov_b32 v46, v45
  s_nop 1
  v_permlane32_swap_b32 v45, v46
  s_nop 0
  v_max_f32 v44, v45, v46
  v_max_f32 v44, v44, v7
  v_sub_f32 v45, v7, v44
  v_exp_f32 v45, v45
  v_mov_b32 v7, v44
  v_sub_f32 v48, v48, v44
  v_sub_f32 v49, v49, v44
  v_sub_f32 v50, v50, v44
  v_sub_f32 v51, v51, v44
  v_sub_f32 v52, v52, v44
  v_sub_f32 v53, v53, v44
  v_sub_f32 v54, v54, v44
  v_sub_f32 v55, v55, v44
  v_sub_f32 v56, v56, v44
  v_sub_f32 v57, v57, v44
  v_sub_f32 v58, v58, v44
  v_sub_f32 v59, v59, v44
  v_sub_f32 v60, v60, v44
  v_sub_f32 v61, v61, v44
  v_sub_f32 v62, v62, v44
  v_sub_f32 v63, v63, v44
  v_mul_f32 v96, v96, v45
  v_mul_f32 v97, v97, v45
  v_mul_f32 v98, v98, v45
  v_mul_f32 v99, v99, v45
  v_mul_f32 v100, v100, v45
  v_mul_f32 v101, v101, v45
  v_mul_f32 v102, v102, v45
  v_mul_f32 v103, v103, v45
  v_mul_f32 v104, v104, v45
  v_mul_f32 v105, v105, v45
  v_mul_f32 v106, v106, v45
  v_mul_f32 v107, v107, v45
  v_mul_f32 v108, v108, v45
  v_mul_f32 v109, v109, v45
  v_mul_f32 v110, v110, v45
  v_mul_f32 v111, v111, v45
  v_exp_f32 v48, v48
  v_exp_f32 v49, v49
  v_exp_f32 v50, v50
  v_exp_f32 v51, v51
  v_exp_f32 v52, v52
  v_exp_f32 v53, v53
  v_exp_f32 v54, v54
  v_exp_f32 v55, v55
  v_exp_f32 v56, v56
  v_exp_f32 v57, v57
  v_exp_f32 v58, v58
  v_exp_f32 v59, v59
  v_exp_f32 v60, v60
  v_exp_f32 v61, v61
  v_exp_f32 v62, v62
  v_exp_f32 v63, v63
  s_nop 0
  v_cvt_pk_bf16_f32 v36, v48, v49
  v_cvt_pk_bf16_f32 v37, v50, v51
  v_cvt_pk_bf16_f32 v38, v52, v53
  v_cvt_pk_bf16_f32 v39, v54, v55
  v_cvt_pk_bf16_f32 v40, v56, v57
  v_cvt_pk_bf16_f32 v41, v58, v59
  v_cvt_pk_bf16_f32 v42, v60, v61
  v_cvt_pk_bf16_f32 v43, v62, v63
  s_nop 1
  v_mfma_f32_32x32x16_bf16 v[96:111], v[20:23], v[36:39], v[96:111]
  v_mfma_f32_32x32x16_bf16 v[96:111], v[24:27], v[40:43], v[96:111]
  v_add_u32 v4, 1024, v4
  v_add_u32 v5, 1024, v5
  s_add_u32 s38, s38, 1
  s_cmp_lt_u32 s38, 64
  s_nop 13
  s_cbranch_scc1 sequential_preLN__softmax_full_mha__glu_gated_reglu__prompt_kernel_fl107
  s_waitcnt vmcnt(0)
  v_rcp_f32 v44, v104
  s_nop 0
  v_mul_f32 v64, v96, v44
  v_mul_f32 v65, v97, v44
  v_mul_f32 v66, v98, v44
  v_mul_f32 v67, v99, v44
  v_mul_f32 v68, v100, v44
  v_mul_f32 v69, v101, v44
  v_mul_f32 v70, v102, v44
  v_mul_f32 v71, v103, v44
  v_cvt_pk_bf16_f32 v36, v64, v65
  v_cvt_pk_bf16_f32 v37, v66, v67
  v_cvt_pk_bf16_f32 v38, v68, v69
  v_cvt_pk_bf16_f32 v39, v70, v71
  buffer_store_dwordx4 v[36:39], v3, s[20:23], s42 offen sc1
  s_branch sequential_preLN__softmax_full_mha__glu_gated_reglu__prompt_kernel_fin71
sequential_preLN__softmax_full_mha__glu_gated_reglu__prompt_kernel_ec6:
  v_mov_b32 v1, 65528
  ds_read_b32 v1, v1
  s_waitcnt lgkmcnt(0)
  v_readfirstlane_b32 s0, v1
  s_nop 0
  s_cmp_eq_u32 s0, 0
  s_cbranch_scc1 sequential_preLN__softmax_full_mha__glu_gated_reglu__prompt_kernel_ecb7
  s_mov_b32 s49, 2
  s_cmp_eq_u32 s0, 2
  s_cbranch_scc1 sequential_preLN__softmax_full_mha__glu_gated_reglu__prompt_kernel_ecb7
  s_branch sequential_preLN__softmax_full_mha__glu_gated_reglu__prompt_kernel_redo
sequential_preLN__softmax_full_mha__glu_gated_reglu__prompt_kernel_ec8:
  v_mov_b32 v1, 65532
  ds_read_b32 v1, v1
  s_waitcnt lgkmcnt(0)
  v_readfirstlane_b32 s0, v1
  s_nop 0
  s_cmp_eq_u32 s0, 0
  s_cbranch_scc1 sequential_preLN__softmax_full_mha__glu_gated_reglu__prompt_kernel_ecb9
  s_mov_b32 s49, 2
  s_cmp_eq_u32 s0, 2
  s_cbranch_scc1 sequential_preLN__softmax_full_mha__glu_gated_reglu__prompt_kernel_ecb9
  s_branch sequential_preLN__softmax_full_mha__glu_gated_reglu__prompt_kernel_redo
sequential_preLN__softmax_full_mha__glu_gated_reglu__prompt_kernel_ec10:
  v_mov_b32 v1, 65528
  ds_read_b32 v1, v1
  s_waitcnt lgkmcnt(0)
  v_readfirstlane_b32 s0, v1
  s_nop 0
  s_cmp_eq_u32 s0, 0
  s_cbranch_scc1 sequential_preLN__softmax_full_mha__glu_gated_reglu__prompt_kernel_ecb11
  s_mov_b32 s49, 2
  s_cmp_eq_u32 s0, 2
  s_cbranch_scc1 sequential_preLN__softmax_full_mha__glu_gated_reglu__prompt_kernel_ecb11
  s_branch sequential_preLN__softmax_full_mha__glu_gated_reglu__prompt_kernel_redo
sequential_preLN__softmax_full_mha__glu_gated_reglu__prompt_kernel_ec12:
  v_mov_b32 v1, 65532
  ds_read_b32 v1, v1
  s_waitcnt lgkmcnt(0)
  v_readfirstlane_b32 s0, v1
  s_nop 0
  s_cmp_eq_u32 s0, 0
  s_cbranch_scc1 sequential_preLN__softmax_full_mha__glu_gated_reglu__prompt_kernel_ecb13
  s_mov_b32 s49, 2
  s_cmp_eq_u32 s0, 2
  s_cbranch_scc1 sequential_preLN__softmax_full_mha__glu_gated_reglu__prompt_kernel_ecb13
  s_branch sequential_preLN__softmax_full_mha__glu_gated_reglu__prompt_kernel_redo
sequential_preLN__softmax_full_mha__glu_gated_reglu__prompt_kernel_ec14:
  v_mov_b32 v1, 65528
  ds_read_b32 v1, v1
  s_waitcnt lgkmcnt(0)
  v_readfirstlane_b32 s0, v1
  s_nop 0
  s_cmp_eq_u32 s0, 0
  s_cbranch_scc1 sequential_preLN__softmax_full_mha__glu_gated_reglu__prompt_kernel_ecb15
  s_mov_b32 s49, 2
  s_cmp_eq_u32 s0, 2
  s_cbranch_scc1 sequential_preLN__softmax_full_mha__glu_gated_reglu__prompt_kernel_ecb15
  s_branch sequential_preLN__softmax_full_mha__glu_gated_reglu__prompt_kernel_redo
sequential_preLN__softmax_full_mha__glu_gated_reglu__prompt_kernel_ec24:
  v_mov_b32 v1, 65528
  ds_read_b32 v1, v1
  s_waitcnt lgkmcnt(0)
  v_readfirstlane_b32 s0, v1
  s_nop 0
  s_cmp_eq_u32 s0, 0
  s_cbranch_scc1 sequential_preLN__softmax_full_mha__glu_gated_reglu__prompt_kernel_ecb25
  s_mov_b32 s49, 2
  s_cmp_eq_u32 s0, 2
  s_cbranch_scc1 sequential_preLN__softmax_full_mha__glu_gated_reglu__prompt_kernel_ecb25
  s_branch sequential_preLN__softmax_full_mha__glu_gated_reglu__prompt_kernel_redo
sequential_preLN__softmax_full_mha__glu_gated_reglu__prompt_kernel_ec28:
  v_mov_b32 v1, 65532
  ds_read_b32 v1, v1
  s_waitcnt lgkmcnt(0)
  v_readfirstlane_b32 s0, v1
  s_nop 0
  s_cmp_eq_u32 s0, 0
  s_cbranch_scc1 sequential_preLN__softmax_full_mha__glu_gated_reglu__prompt_kernel_ecb29
  s_mov_b32 s49, 2
  s_cmp_eq_u32 s0, 2
  s_cbranch_scc1 sequential_preLN__softmax_full_mha__glu_gated_reglu__prompt_kernel_ecb29
  s_branch sequential_preLN__softmax_full_mha__glu_gated_reglu__prompt_kernel_redo
sequential_preLN__softmax_full_mha__glu_gated_reglu__prompt_kernel_ec32:
  v_mov_b32 v1, 65528
  ds_read_b32 v1, v1
  s_waitcnt lgkmcnt(0)
  v_readfirstlane_b32 s0, v1
  s_nop 0
  s_cmp_eq_u32 s0, 0
  s_cbranch_scc1 sequential_preLN__softmax_full_mha__glu_gated_reglu__prompt_kernel_ecb33
  s_mov_b32 s49, 2
  s_cmp_eq_u32 s0, 2
  s_cbranch_scc1 sequential_preLN__softmax_full_mha__glu_gated_reglu__prompt_kernel_ecb33
  s_branch sequential_preLN__softmax_full_mha__glu_gated_reglu__prompt_kernel_redo
sequential_preLN__softmax_full_mha__glu_gated_reglu__prompt_kernel_ec36:
  v_mov_b32 v1, 65532
  ds_read_b32 v1, v1
  s_waitcnt lgkmcnt(0)
  v_readfirstlane_b32 s0, v1
  s_nop 0
  s_cmp_eq_u32 s0, 0
  s_cbranch_scc1 sequential_preLN__softmax_full_mha__glu_gated_reglu__prompt_kernel_ecb37
  s_mov_b32 s49, 2
  s_cmp_eq_u32 s0, 2
  s_cbranch_scc1 sequential_preLN__softmax_full_mha__glu_gated_reglu__prompt_kernel_ecb37
  s_branch sequential_preLN__softmax_full_mha__glu_gated_reglu__prompt_kernel_redo
sequential_preLN__softmax_full_mha__glu_gated_reglu__prompt_kernel_ec40:
  v_mov_b32 v1, 65528
  ds_read_b32 v1, v1
  s_waitcnt lgkmcnt(0)
  v_readfirstlane_b32 s0, v1
  s_nop 0
  s_cmp_eq_u32 s0, 0
  s_cbranch_scc1 sequential_preLN__softmax_full_mha__glu_gated_reglu__prompt_kernel_ecb41
  s_mov_b32 s49, 2
  s_cmp_eq_u32 s0, 2
  s_cbranch_scc1 sequential_preLN__softmax_full_mha__glu_gated_reglu__prompt_kernel_ecb41
  s_branch sequential_preLN__softmax_full_mha__glu_gated_reglu__prompt_kernel_redo
sequential_preLN__softmax_full_mha__glu_gated_reglu__prompt_kernel_ec56:
  v_mov_b32 v1, 65528
  ds_read_b32 v1, v1
  s_waitcnt lgkmcnt(0)
  v_readfirstlane_b32 s0, v1
  s_nop 0
  s_cmp_eq_u32 s0, 0
  s_cbranch_scc1 sequential_preLN__softmax_full_mha__glu_gated_reglu__prompt_kernel_ecb57
  s_mov_b32 s49, 2
  s_cmp_eq_u32 s0, 2
  s_cbranch_scc1 sequential_preLN__softmax_full_mha__glu_gated_reglu__prompt_kernel_ecb57
  s_branch sequential_preLN__softmax_full_mha__glu_gated_reglu__prompt_kernel_redo
sequential_preLN__softmax_full_mha__glu_gated_reglu__prompt_kernel_ec61:
  s_cmp_eq_u32 s47, 3
  s_cselect_b32 s49, 2, 1
  s_and_b32 s0, s47, 1
  s_lshl_b32 s0, s0, 2
  s_sub_u32 s0, 65532, s0
  v_mov_b32 v1, s0
  ds_read_b32 v1, v1
  s_waitcnt lgkmcnt(0)
  v_readfirstlane_b32 s0, v1
  s_nop 0
  s_cmp_eq_u32 s0, 0
  s_cbranch_scc1 sequential_preLN__softmax_full_mha__glu_gated_reglu__prompt_kernel_ecb62
  s_mov_b32 s49, 2
  s_cmp_eq_u32 s0, 2
  s_cbranch_scc1 sequential_preLN__softmax_full_mha__glu_gated_reglu__prompt_kernel_ecb62
  s_branch sequential_preLN__softmax_full_mha__glu_gated_reglu__prompt_kernel_redo
sequential_preLN__softmax_full_mha__glu_gated_reglu__prompt_kernel_ec64:
  s_cmp_eq_u32 s47, 3
  s_cselect_b32 s49, 2, 1
  s_and_b32 s0, s47, 1
  s_lshl_b32 s0, s0, 2
  s_sub_u32 s0, 65532, s0
  v_mov_b32 v1, s0
  ds_read_b32 v1, v1
  s_waitcnt lgkmcnt(0)
  v_readfirstlane_b32 s0, v1
  s_nop 0
  s_cmp_eq_u32 s0, 0
  s_cbranch_scc1 sequential_preLN__softmax_full_mha__glu_gated_reglu__prompt_kernel_ecb65
  s_mov_b32 s49, 2
  s_cmp_eq_u32 s0, 2
  s_cbranch_scc1 sequential_preLN__softmax_full_mha__glu_gated_reglu__prompt_kernel_ecb65
  s_branch sequential_preLN__softmax_full_mha__glu_gated_reglu__prompt_kernel_redo
sequential_preLN__softmax_full_mha__glu_gated_reglu__prompt_kernel_redo:
  s_and_b32 s25, s0, 31
  s_mov_b32 s3, 2
  s_mov_b32 s49, 0
  s_cmp_eq_u32 s0, 1
  s_cbranch_scc0 sequential_preLN__softmax_full_mha__glu_gated_reglu__prompt_kernel_redo1
  s_and_b32 s24, s2, 7
  s_lshr_b32 s25, s2, 3
  s_mov_b32 s3, 1
sequential_preLN__softmax_full_mha__glu_gated_reglu__prompt_kernel_redo1:
  s_waitcnt vmcnt(0)
  s_barrier
  s_branch sequential_preLN__softmax_full_mha__glu_gated_reglu__prompt_kernel_restart
  .fill (40960 - (. - sequential_preLN__softmax_full_mha__glu_gated_reglu__prompt_kernel))/4, 4, 0xbf810000
.section .rodata,"a"
.p2align 6
.amdhsa_kernel sequential_preLN__softmax_full_mha__glu_gated_reglu__prompt_kernel
  .amdhsa_next_free_vgpr 168
  .amdhsa_next_free_sgpr 64
  .amdhsa_accum_offset 168
  .amdhsa_group_segment_fixed_size 0
  .amdhsa_kernarg_size 80
  .amdhsa_user_sgpr_count 2
  .amdhsa_user_sgpr_kernarg_segment_ptr 1
  .amdhsa_system_sgpr_workgroup_id_x 1
.end_amdhsa_kernel
```
